```python
import torch

def _softmax(x, axis=-1):
    return torch.softmax(x, dim=axis)
def _gelu(x):
    return torch.nn.functional.gelu(x, approximate="tanh")
def _silu(x):
    return torch.nn.functional.silu(x)
def _sigmoid(x):
    return torch.sigmoid(x)
def _layernorm(x, axis=-1, eps=1e-5):
    m = x.mean(dim=axis, keepdim=True)
    v = x.var(dim=axis, keepdim=True, unbiased=False)
    return (x - m) / torch.sqrt(v + eps)
def _scatter_add(tgt, idx, src, axis=0):
    return tgt.clone().index_add_(axis, idx, src)
def _segment_sum(src, seg, n):
    out = torch.zeros((n,) + src.shape[1:], dtype=src.dtype)
    return out.index_add_(0, seg, src)
def _pad(x, pw):
    flat = tuple(v for pair in reversed(pw) for v in pair)
    return torch.nn.functional.pad(x, flat)

kernel_name = 'concat_heads__spectral_fnet__softmax_full_mha__prompt'

def setup_inputs():

    _w = (lambda a: (lambda t: t.to(torch.bfloat16) if t.is_floating_point() else t)(torch.as_tensor(a)))
    def _A_setup():
        B, S, D = 1, 2048, 576
        ns = torch.arange(S)[:, None] * torch.arange(S)[None, :]
        nd = torch.arange(D)[:, None] * torch.arange(D)[None, :]
        Ws_re = torch.cos(-2.0 * torch.pi * ns / S).to(float)
        Ws_im = torch.sin(-2.0 * torch.pi * ns / S).to(float)
        Wd_re = torch.cos(-2.0 * torch.pi * nd / D).to(float)
        Wd_im = torch.sin(-2.0 * torch.pi * nd / D).to(float)
        return {
            "x": _w((lambda *s: torch.randn(*s, dtype=torch.bfloat16) * 0.05)(B, S, D)),
            "dft_seq_re": _w(Ws_re),
            "dft_seq_im": _w(Ws_im),
            "dft_hid_re": _w(Wd_re),
            "dft_hid_im": _w(Wd_im),
        }
    _A_in = _A_setup()

    def _B_setup():
        B, S, D = 1, 2048, 576
        return {
            "x": _w((lambda *s: torch.randn(*s, dtype=torch.bfloat16) * 0.2)(B, S, D)),
            "wqkv": _w((lambda *s: torch.randn(*s, dtype=torch.bfloat16) * 0.8)(D, 3 * D)),
            "wo": _w((lambda *s: torch.randn(*s, dtype=torch.bfloat16) * 0.2)(D, D)),
        }
    _B_in = _B_setup()

    return {
        "A_x": _A_in["x"],
        "A_dft_seq_re": _A_in["dft_seq_re"],
        "A_dft_seq_im": _A_in["dft_seq_im"],
        "A_dft_hid_re": _A_in["dft_hid_re"],
        "A_dft_hid_im": _A_in["dft_hid_im"],
        "B_x": _B_in["x"],
        "B_wqkv": _B_in["wqkv"],
        "B_wo": _B_in["wo"],
    }

def reference(A_x, A_dft_seq_re, A_dft_seq_im, A_dft_hid_re, A_dft_hid_im, B_x, B_wqkv, B_wo):
    def _A_ref(x, dft_seq_re, dft_seq_im, dft_hid_re, dft_hid_im):
        a = torch.einsum("bsd,ed->bse", x, dft_hid_re)
        b = torch.einsum("bsd,ed->bse", x, dft_hid_im)
        y = torch.einsum("ts,bse->bte", dft_seq_re, a) - torch.einsum("ts,bse->bte", dft_seq_im, b)
        return y

    def _B_ref(x, wqkv, wo):
        B, S, D = x.shape
        H = 32; Dh = D // H
        qkv = (lambda x, *d: x.permute(*d))((x @ wqkv).reshape(B, S, 3, H, Dh), 2, 0, 3, 1, 4)
        q, k, v = qkv[0], qkv[1], qkv[2]
        scale = Dh ** -0.5
        scores = torch.einsum("bhqd,bhkd->bhqk", q, k) * scale
        p = _softmax(scores, axis=-1)
        o = torch.einsum("bhqk,bhkd->bhqd", p, v)
        return (lambda x, *d: x.permute(*d))(o, 0, 2, 1, 3).reshape(B, S, D) @ wo

    a = _A_ref(A_x, A_dft_seq_re, A_dft_seq_im, A_dft_hid_re, A_dft_hid_im)
    b = _B_ref(B_x, B_wqkv, B_wo)
    return torch.concatenate([a, b], axis=-1)
```

```asm
; @launch grid=(256,1,1) block=(768,1,1) lds=163840
.amdgcn_target "amdgcn-amd-amdhsa--gfx950"
.text
.globl concat_heads__spectral_fnet__softmax_full_mha__prompt_kernel
.p2align 8
.type concat_heads__spectral_fnet__softmax_full_mha__prompt_kernel,@function
concat_heads__spectral_fnet__softmax_full_mha__prompt_kernel:
    s_cmp_ge_u32 s2, 256
    s_cbranch_scc1 L_end
    s_load_dwordx4 s[52:55], s[0:1], 40
    s_load_dwordx4 s[4:7], s[0:1], 72
    s_load_dwordx4 s[40:43], s[0:1], 56
    s_load_dwordx2 s[48:49], s[0:1], 0
    s_memtime s[56:57]
    s_memrealtime s[58:59]
    v_lshrrev_b32 v1, 6, v0
    s_and_b32 s27, s2, 7
    s_lshr_b32 s26, s2, 3
    s_lshr_b32 s25, s26, 2
    s_add_u32 s24, s26, s25
    s_and_b32 s24, s24, 3
    s_and_b32 s28, s27, 3
    s_lshl_b32 s24, s24, 2
    s_add_u32 s24, s24, s28
    s_lshr_b32 s28, s27, 2
    s_lshl_b32 s25, s25, 1
    s_add_u32 s25, s25, s28
    s_lshl_b32 s21, s27, 2
    s_lshr_b32 s28, s26, 3
    s_add_u32 s21, s21, s28
    s_and_b32 s22, s26, 7
    v_readfirstlane_b32 s3, v1
    v_and_b32 v1, 63, v0
    s_mov_b32 s62, 0
    s_mov_b32 s63, 255
    s_waitcnt lgkmcnt(0)
    s_mov_b32 s12, s52
    s_mov_b32 s13, s53
    s_mov_b32 s14, 2359296
    s_mov_b32 s15, 0x00020000
    s_mov_b32 s16, s54
    s_mov_b32 s17, s55
    s_mov_b32 s18, 1990656
    s_mov_b32 s19, 0x00020000
    s_mov_b32 s8, s6
    s_mov_b32 s9, s7
    s_mov_b32 s10, 268435456
    s_mov_b32 s11, 0x00020000
    s_mov_b32 s44, s4
    s_mov_b32 s45, s5
    s_mov_b32 s46, 256
    s_mov_b32 s47, 0x00020000
    s_mov_b32 s20, s56
    s_mov_b32 s7, s58
    s_lshr_b32 s27, s3, 2
    s_lshr_b32 s28, s26, 2
    s_cmp_eq_u32 s28, 7
    s_cselect_b32 s27, 0, s27
    s_cmp_eq_u32 s27, 1
    s_cbranch_scc1 L_lw
    s_cmp_lg_u32 s3, 11
    s_cbranch_scc1 L_pr1
    v_lshlrev_b32 v2, 2, v1
    v_add_u32 v2, 159744, v2
    v_mov_b32 v3, 0
    ds_write_b32 v2, v3
    s_waitcnt lgkmcnt(0)
L_pr1:
    s_cmp_eq_u32 s28, 7
    s_cbranch_scc1 L_pr2
    s_barrier
    s_cmp_lt_u32 s3, 4
    s_cbranch_scc1 L_mw
L_pr2:
    s_cmp_ge_u32 s3, 8
    s_cbranch_scc1 L_hw
    s_branch L_fn
L_lw:
    s_sub_u32 s26, s3, 4
    s_and_b32 s27, s26, 1
    s_lshl_b32 s28, s27, 2
    v_and_b32 v3, 7, v1
    v_xor_b32 v3, s28, v3
    v_lshrrev_b32 v4, 3, v1
    v_mul_u32_u24 v4, 1152, v4
    v_lshl_add_u32 v8, v3, 4, v4
    v_lshrrev_b32 v2, 4, v1
    v_lshlrev_b32 v3, 2, v2
    v_and_b32 v4, 15, v1
    v_xor_b32 v3, v3, v4
    v_lshrrev_b32 v4, 1, v2
    v_and_b32 v2, 1, v2
    v_lshl_add_u32 v2, v4, 3, v2
    v_mul_u32_u24 v4, 3456, v2
    v_lshl_add_u32 v9, v3, 4, v4
    s_lshl_b32 s28, s24, 7
    s_lshl_b32 s29, s26, 3
    s_add_u32 s28, s28, s29
    s_mul_i32 s28, s28, 1152
    s_lshl_b32 s29, s27, 4
    s_and_b32 s30, s26, 2
    s_add_u32 s29, s29, s30
    s_mul_i32 s29, s29, 3456
    s_lshl_b32 s30, s25, 8
    s_add_u32 s29, s29, s30
    s_lshl_b32 s30, s26, 10
    s_mov_b32 s37, s30
    s_add_u32 s31, s24, s25
    s_mul_i32 s32, s31, 7282
    s_lshr_b32 s32, s32, 16
    s_mul_i32 s32, s32, 9
    s_sub_u32 s31, s31, s32
    v_add_u32 v10, 36864, v8
    v_add_u32 v11, 73728, v8
    v_add_u32 v12, 110592, v8
    s_add_u32 s30, s30, 49152
    s_lshl_b32 s32, s31, 7
    s_add_u32 s32, s32, s28
    s_mul_i32 s33, s31, 221184
    s_add_u32 s33, s33, s29
    s_add_u32 s31, s31, 1
    s_cmp_eq_u32 s31, 9
    s_cselect_b32 s31, 0, s31
    s_add_u32 m0, s30, 0
    buffer_load_dwordx4 v[16:19], v8, s[12:15], s32 offen
    buffer_load_dwordx4 v9, s[16:19], s33 offen  lds
    s_add_u32 m0, s30, 4096
    buffer_load_dwordx4 v[20:23], v10, s[12:15], s32 offen
    s_add_u32 s33, s33, 13824
    buffer_load_dwordx4 v9, s[16:19], s33 offen  lds
    s_add_u32 m0, s30, 8192
    buffer_load_dwordx4 v[24:27], v11, s[12:15], s32 offen
    s_add_u32 s33, s33, 96768
    buffer_load_dwordx4 v9, s[16:19], s33 offen  lds
    s_add_u32 m0, s30, 12288
    buffer_load_dwordx4 v[28:31], v12, s[12:15], s32 offen
    s_add_u32 s33, s33, 13824
    buffer_load_dwordx4 v9, s[16:19], s33 offen  lds
    s_add_u32 s30, s30, 16384
    v_mov_b32 v3, 196608
    s_mov_b32 s27, 159744
    v_mov_b32 v4, 1
    v_writelane_b32 v3, s27, 0
    s_barrier
    s_lshl_b32 s32, s31, 7
    s_add_u32 s32, s32, s28
    s_mul_i32 s33, s31, 221184
    s_add_u32 s33, s33, s29
    s_add_u32 s31, s31, 1
    s_cmp_eq_u32 s31, 9
    s_cselect_b32 s31, 0, s31
    s_add_u32 m0, s30, 0
    buffer_load_dwordx4 v[32:35], v8, s[12:15], s32 offen
    buffer_load_dwordx4 v9, s[16:19], s33 offen  lds
    s_add_u32 m0, s30, 4096
    buffer_load_dwordx4 v[36:39], v10, s[12:15], s32 offen
    s_add_u32 s33, s33, 13824
    buffer_load_dwordx4 v9, s[16:19], s33 offen  lds
    s_add_u32 m0, s30, 8192
    buffer_load_dwordx4 v[40:43], v11, s[12:15], s32 offen
    s_add_u32 s33, s33, 96768
    buffer_load_dwordx4 v9, s[16:19], s33 offen  lds
    s_add_u32 m0, s30, 12288
    buffer_load_dwordx4 v[44:47], v12, s[12:15], s32 offen
    s_add_u32 s33, s33, 13824
    buffer_load_dwordx4 v9, s[16:19], s33 offen  lds
    s_add_u32 s30, s30, 16384
    s_mov_b32 m0, s37
    s_waitcnt vmcnt(15)
    ds_write_addtid_b32 v16 offset:0
    ds_write_addtid_b32 v17 offset:256
    ds_write_addtid_b32 v18 offset:512
    ds_write_addtid_b32 v19 offset:768
    s_mov_b32 m0, s37
    s_waitcnt vmcnt(13)
    ds_write_addtid_b32 v20 offset:4096
    ds_write_addtid_b32 v21 offset:4352
    ds_write_addtid_b32 v22 offset:4608
    ds_write_addtid_b32 v23 offset:4864
    s_mov_b32 m0, s37
    s_waitcnt vmcnt(11)
    ds_write_addtid_b32 v24 offset:8192
    ds_write_addtid_b32 v25 offset:8448
    ds_write_addtid_b32 v26 offset:8704
    ds_write_addtid_b32 v27 offset:8960
    s_mov_b32 m0, s37
    s_waitcnt vmcnt(9)
    ds_write_addtid_b32 v28 offset:12288
    ds_write_addtid_b32 v29 offset:12544
    ds_write_addtid_b32 v30 offset:12800
    ds_write_addtid_b32 v31 offset:13056
    s_waitcnt vmcnt(8)
    ds_add_u32 v3, v4 offset:0
    v_add_u32 v3, 4, v3
    s_lshl_b32 s32, s31, 7
    s_add_u32 s32, s32, s28
    s_mul_i32 s33, s31, 221184
    s_add_u32 s33, s33, s29
    s_add_u32 s31, s31, 1
    s_cmp_eq_u32 s31, 9
    s_cselect_b32 s31, 0, s31
    s_add_u32 m0, s30, 0
    buffer_load_dwordx4 v[48:51], v8, s[12:15], s32 offen
    buffer_load_dwordx4 v9, s[16:19], s33 offen  lds
    s_add_u32 m0, s30, 4096
    buffer_load_dwordx4 v[52:55], v10, s[12:15], s32 offen
    s_add_u32 s33, s33, 13824
    buffer_load_dwordx4 v9, s[16:19], s33 offen  lds
    s_add_u32 m0, s30, 8192
    buffer_load_dwordx4 v[56:59], v11, s[12:15], s32 offen
    s_add_u32 s33, s33, 96768
    buffer_load_dwordx4 v9, s[16:19], s33 offen  lds
    s_add_u32 m0, s30, 12288
    buffer_load_dwordx4 v[60:63], v12, s[12:15], s32 offen
    s_add_u32 s33, s33, 13824
    buffer_load_dwordx4 v9, s[16:19], s33 offen  lds
    s_add_u32 s30, s30, 16384
    s_lshl_b32 s32, s31, 7
    s_add_u32 s32, s32, s28
    s_mul_i32 s33, s31, 221184
    s_add_u32 s33, s33, s29
    s_add_u32 s31, s31, 1
    s_cmp_eq_u32 s31, 9
    s_cselect_b32 s31, 0, s31
    s_add_u32 m0, s30, 0
    buffer_load_dwordx4 v[16:19], v8, s[12:15], s32 offen
    buffer_load_dwordx4 v9, s[16:19], s33 offen  lds
    s_add_u32 m0, s30, 4096
    buffer_load_dwordx4 v[20:23], v10, s[12:15], s32 offen
    s_add_u32 s33, s33, 13824
    buffer_load_dwordx4 v9, s[16:19], s33 offen  lds
    s_add_u32 m0, s30, 8192
    buffer_load_dwordx4 v[24:27], v11, s[12:15], s32 offen
    s_add_u32 s33, s33, 96768
    buffer_load_dwordx4 v9, s[16:19], s33 offen  lds
    s_add_u32 m0, s30, 12288
    buffer_load_dwordx4 v[28:31], v12, s[12:15], s32 offen
    s_add_u32 s33, s33, 13824
    buffer_load_dwordx4 v9, s[16:19], s33 offen  lds
    s_add_u32 s30, s30, 16384
    s_mov_b32 s35, 0
L_ld_loop:
    s_cmp_eq_u32 s35, 0
    s_cbranch_scc1 L_ld_go1
L_ld_fr1:
    ds_read_b32 v5, v3 offset:36
    s_waitcnt lgkmcnt(0)
    v_readfirstlane_b32 s36, v5
    s_cmp_ge_u32 s36, 4
    s_cbranch_scc0 L_ld_fr1
L_ld_go1:
    s_lshl_b32 s32, s31, 7
    s_add_u32 s32, s32, s28
    s_mul_i32 s33, s31, 221184
    s_add_u32 s33, s33, s29
    s_add_u32 s31, s31, 1
    s_cmp_eq_u32 s31, 9
    s_cselect_b32 s31, 0, s31
    s_mov_b32 m0, s37
    s_waitcnt vmcnt(23)
    ds_write_addtid_b32 v32 offset:16384
    ds_write_addtid_b32 v33 offset:16640
    ds_write_addtid_b32 v34 offset:16896
    ds_write_addtid_b32 v35 offset:17152
    s_add_u32 m0, s30, 0
    buffer_load_dwordx4 v[32:35], v8, s[12:15], s32 offen
    buffer_load_dwordx4 v9, s[16:19], s33 offen  lds
    s_mov_b32 m0, s37
    s_waitcnt vmcnt(23)
    ds_write_addtid_b32 v36 offset:20480
    ds_write_addtid_b32 v37 offset:20736
    ds_write_addtid_b32 v38 offset:20992
    ds_write_addtid_b32 v39 offset:21248
    s_add_u32 m0, s30, 4096
    buffer_load_dwordx4 v[36:39], v10, s[12:15], s32 offen
    s_add_u32 s33, s33, 13824
    buffer_load_dwordx4 v9, s[16:19], s33 offen  lds
    s_mov_b32 m0, s37
    s_waitcnt vmcnt(23)
    ds_write_addtid_b32 v40 offset:24576
    ds_write_addtid_b32 v41 offset:24832
    ds_write_addtid_b32 v42 offset:25088
    ds_write_addtid_b32 v43 offset:25344
    s_add_u32 m0, s30, 8192
    buffer_load_dwordx4 v[40:43], v11, s[12:15], s32 offen
    s_add_u32 s33, s33, 96768
    buffer_load_dwordx4 v9, s[16:19], s33 offen  lds
    s_mov_b32 m0, s37
    s_waitcnt vmcnt(23)
    ds_write_addtid_b32 v44 offset:28672
    ds_write_addtid_b32 v45 offset:28928
    ds_write_addtid_b32 v46 offset:29184
    ds_write_addtid_b32 v47 offset:29440
    s_waitcnt vmcnt(22)
    ds_add_u32 v3, v4 offset:0
    v_add_u32 v3, 4, v3
    s_add_u32 m0, s30, 12288
    buffer_load_dwordx4 v[44:47], v12, s[12:15], s32 offen
    s_add_u32 s33, s33, 13824
    buffer_load_dwordx4 v9, s[16:19], s33 offen  lds
    s_add_u32 s30, s30, 16384
    s_cmp_eq_u32 s35, 0
    s_cbranch_scc1 L_ld_go2
L_ld_fr2:
    ds_read_b32 v5, v3 offset:36
    s_waitcnt lgkmcnt(0)
    v_readfirstlane_b32 s36, v5
    s_cmp_ge_u32 s36, 4
    s_cbranch_scc0 L_ld_fr2
L_ld_go2:
    s_lshl_b32 s32, s31, 7
    s_add_u32 s32, s32, s28
    s_mul_i32 s33, s31, 221184
    s_add_u32 s33, s33, s29
    s_add_u32 s31, s31, 1
    s_cmp_eq_u32 s31, 9
    s_cselect_b32 s31, 0, s31
    s_mov_b32 m0, s37
    s_waitcnt vmcnt(23)
    ds_write_addtid_b32 v48 offset:32768
    ds_write_addtid_b32 v49 offset:33024
    ds_write_addtid_b32 v50 offset:33280
    ds_write_addtid_b32 v51 offset:33536
    s_add_u32 m0, s30, 0
    buffer_load_dwordx4 v[48:51], v8, s[12:15], s32 offen
    buffer_load_dwordx4 v9, s[16:19], s33 offen  lds
    s_mov_b32 m0, s37
    s_waitcnt vmcnt(23)
    ds_write_addtid_b32 v52 offset:36864
    ds_write_addtid_b32 v53 offset:37120
    ds_write_addtid_b32 v54 offset:37376
    ds_write_addtid_b32 v55 offset:37632
    s_add_u32 m0, s30, 4096
    buffer_load_dwordx4 v[52:55], v10, s[12:15], s32 offen
    s_add_u32 s33, s33, 13824
    buffer_load_dwordx4 v9, s[16:19], s33 offen  lds
    s_mov_b32 m0, s37
    s_waitcnt vmcnt(23)
    ds_write_addtid_b32 v56 offset:40960
    ds_write_addtid_b32 v57 offset:41216
    ds_write_addtid_b32 v58 offset:41472
    ds_write_addtid_b32 v59 offset:41728
    s_add_u32 m0, s30, 8192
    buffer_load_dwordx4 v[56:59], v11, s[12:15], s32 offen
    s_add_u32 s33, s33, 96768
    buffer_load_dwordx4 v9, s[16:19], s33 offen  lds
    s_mov_b32 m0, s37
    s_waitcnt vmcnt(23)
    ds_write_addtid_b32 v60 offset:45056
    ds_write_addtid_b32 v61 offset:45312
    ds_write_addtid_b32 v62 offset:45568
    ds_write_addtid_b32 v63 offset:45824
    s_waitcnt vmcnt(22)
    ds_add_u32 v3, v4 offset:0
    v_add_u32 v3, 4, v3
    s_add_u32 m0, s30, 12288
    buffer_load_dwordx4 v[60:63], v12, s[12:15], s32 offen
    s_add_u32 s33, s33, 13824
    buffer_load_dwordx4 v9, s[16:19], s33 offen  lds
    s_add_u32 s30, s30, 16384
    s_cmp_eq_u32 s35, 1
    s_cbranch_scc1 L_ld_tail
L_ld_fr0:
    ds_read_b32 v5, v3 offset:36
    s_waitcnt lgkmcnt(0)
    v_readfirstlane_b32 s36, v5
    s_cmp_ge_u32 s36, 4
    s_cbranch_scc0 L_ld_fr0
    s_sub_u32 s30, s30, 98304
L_ld_go0:
    s_lshl_b32 s32, s31, 7
    s_add_u32 s32, s32, s28
    s_mul_i32 s33, s31, 221184
    s_add_u32 s33, s33, s29
    s_add_u32 s31, s31, 1
    s_cmp_eq_u32 s31, 9
    s_cselect_b32 s31, 0, s31
    s_mov_b32 m0, s37
    s_waitcnt vmcnt(23)
    ds_write_addtid_b32 v16 offset:0
    ds_write_addtid_b32 v17 offset:256
    ds_write_addtid_b32 v18 offset:512
    ds_write_addtid_b32 v19 offset:768
    s_add_u32 m0, s30, 0
    buffer_load_dwordx4 v[16:19], v8, s[12:15], s32 offen
    buffer_load_dwordx4 v9, s[16:19], s33 offen  lds
    s_mov_b32 m0, s37
    s_waitcnt vmcnt(23)
    ds_write_addtid_b32 v20 offset:4096
    ds_write_addtid_b32 v21 offset:4352
    ds_write_addtid_b32 v22 offset:4608
    ds_write_addtid_b32 v23 offset:4864
    s_add_u32 m0, s30, 4096
    buffer_load_dwordx4 v[20:23], v10, s[12:15], s32 offen
    s_add_u32 s33, s33, 13824
    buffer_load_dwordx4 v9, s[16:19], s33 offen  lds
    s_mov_b32 m0, s37
    s_waitcnt vmcnt(23)
    ds_write_addtid_b32 v24 offset:8192
    ds_write_addtid_b32 v25 offset:8448
    ds_write_addtid_b32 v26 offset:8704
    ds_write_addtid_b32 v27 offset:8960
    s_add_u32 m0, s30, 8192
    buffer_load_dwordx4 v[24:27], v11, s[12:15], s32 offen
    s_add_u32 s33, s33, 96768
    buffer_load_dwordx4 v9, s[16:19], s33 offen  lds
    s_mov_b32 m0, s37
    s_waitcnt vmcnt(23)
    ds_write_addtid_b32 v28 offset:12288
    ds_write_addtid_b32 v29 offset:12544
    ds_write_addtid_b32 v30 offset:12800
    ds_write_addtid_b32 v31 offset:13056
    s_waitcnt vmcnt(22)
    ds_add_u32 v3, v4 offset:0
    v_add_u32 v3, 4, v3
    s_add_u32 m0, s30, 12288
    buffer_load_dwordx4 v[28:31], v12, s[12:15], s32 offen
    s_add_u32 s33, s33, 13824
    buffer_load_dwordx4 v9, s[16:19], s33 offen  lds
    s_add_u32 s30, s30, 16384
    s_add_u32 s35, s35, 1
    s_branch L_ld_loop
L_ld_tail:
L_ld_ft0:
    ds_read_b32 v5, v3 offset:36
    s_waitcnt lgkmcnt(0)
    v_readfirstlane_b32 s36, v5
    s_cmp_ge_u32 s36, 4
    s_cbranch_scc0 L_ld_ft0
    s_mov_b32 m0, s37
    s_waitcnt vmcnt(23)
    ds_write_addtid_b32 v16 offset:0
    ds_write_addtid_b32 v17 offset:256
    ds_write_addtid_b32 v18 offset:512
    ds_write_addtid_b32 v19 offset:768
    s_mov_b32 m0, s37
    s_waitcnt vmcnt(21)
    ds_write_addtid_b32 v20 offset:4096
    ds_write_addtid_b32 v21 offset:4352
    ds_write_addtid_b32 v22 offset:4608
    ds_write_addtid_b32 v23 offset:4864
    s_mov_b32 m0, s37
    s_waitcnt vmcnt(19)
    ds_write_addtid_b32 v24 offset:8192
    ds_write_addtid_b32 v25 offset:8448
    ds_write_addtid_b32 v26 offset:8704
    ds_write_addtid_b32 v27 offset:8960
    s_mov_b32 m0, s37
    s_waitcnt vmcnt(17)
    ds_write_addtid_b32 v28 offset:12288
    ds_write_addtid_b32 v29 offset:12544
    ds_write_addtid_b32 v30 offset:12800
    ds_write_addtid_b32 v31 offset:13056
    s_waitcnt vmcnt(16)
    ds_add_u32 v3, v4 offset:0
    v_add_u32 v3, 4, v3
L_ld_ft1:
    ds_read_b32 v5, v3 offset:36
    s_waitcnt lgkmcnt(0)
    v_readfirstlane_b32 s36, v5
    s_cmp_ge_u32 s36, 4
    s_cbranch_scc0 L_ld_ft1
    s_mov_b32 m0, s37
    s_waitcnt vmcnt(15)
    ds_write_addtid_b32 v32 offset:16384
    ds_write_addtid_b32 v33 offset:16640
    ds_write_addtid_b32 v34 offset:16896
    ds_write_addtid_b32 v35 offset:17152
    s_mov_b32 m0, s37
    s_waitcnt vmcnt(13)
    ds_write_addtid_b32 v36 offset:20480
    ds_write_addtid_b32 v37 offset:20736
    ds_write_addtid_b32 v38 offset:20992
    ds_write_addtid_b32 v39 offset:21248
    s_mov_b32 m0, s37
    s_waitcnt vmcnt(11)
    ds_write_addtid_b32 v40 offset:24576
    ds_write_addtid_b32 v41 offset:24832
    ds_write_addtid_b32 v42 offset:25088
    ds_write_addtid_b32 v43 offset:25344
    s_mov_b32 m0, s37
    s_waitcnt vmcnt(9)
    ds_write_addtid_b32 v44 offset:28672
    ds_write_addtid_b32 v45 offset:28928
    ds_write_addtid_b32 v46 offset:29184
    ds_write_addtid_b32 v47 offset:29440
    s_waitcnt vmcnt(8)
    ds_add_u32 v3, v4 offset:0
    v_add_u32 v3, 4, v3
L_ld_ft2:
    ds_read_b32 v5, v3 offset:36
    s_waitcnt lgkmcnt(0)
    v_readfirstlane_b32 s36, v5
    s_cmp_ge_u32 s36, 4
    s_cbranch_scc0 L_ld_ft2
    s_mov_b32 m0, s37
    s_waitcnt vmcnt(7)
    ds_write_addtid_b32 v48 offset:32768
    ds_write_addtid_b32 v49 offset:33024
    ds_write_addtid_b32 v50 offset:33280
    ds_write_addtid_b32 v51 offset:33536
    s_mov_b32 m0, s37
    s_waitcnt vmcnt(5)
    ds_write_addtid_b32 v52 offset:36864
    ds_write_addtid_b32 v53 offset:37120
    ds_write_addtid_b32 v54 offset:37376
    ds_write_addtid_b32 v55 offset:37632
    s_mov_b32 m0, s37
    s_waitcnt vmcnt(3)
    ds_write_addtid_b32 v56 offset:40960
    ds_write_addtid_b32 v57 offset:41216
    ds_write_addtid_b32 v58 offset:41472
    ds_write_addtid_b32 v59 offset:41728
    s_mov_b32 m0, s37
    s_waitcnt vmcnt(1)
    ds_write_addtid_b32 v60 offset:45056
    ds_write_addtid_b32 v61 offset:45312
    ds_write_addtid_b32 v62 offset:45568
    ds_write_addtid_b32 v63 offset:45824
    s_waitcnt vmcnt(0)
    ds_add_u32 v3, v4 offset:0
    v_add_u32 v3, 4, v3
    v_mov_b32 v14, 159744
    v_mov_b32 v160, 1073741824
    v_mov_b32 v161, 1073741824
    v_mov_b32 v162, 1073741824
    v_mov_b32 v163, 1073741824
    v_mov_b32 v164, 1073741824
    v_mov_b32 v165, 1073741824
    v_mov_b32 v166, 1073741824
    v_mov_b32 v167, 1073741824
L_l_n:
    ds_read_b32 v5, v14 offset:100
    s_waitcnt lgkmcnt(0)
    v_readfirstlane_b32 s39, v5
    s_cmp_eq_u32 s39, 0
    s_cbranch_scc1 L_l_n
    s_branch L_attn
L_hw:
    s_sub_u32 s23, s3, 8
    s_cmp_lg_u32 s3, 11
    s_cbranch_scc1 L_h0
    s_cmp_lg_u32 s2, 0
    s_cbranch_scc1 L_h00
    s_memrealtime s[30:31]
    s_waitcnt lgkmcnt(0)
    s_or_b32 s30, s30, 1
    v_mov_b32 v4, s30
    s_mov_b64 exec, 1
    buffer_store_dword v4, off, s[44:47], 0 sc1
    s_mov_b64 exec, -1
L_h00:
    s_cmp_ge_u32 s26, 28
    s_cbranch_scc1 L_fn
    v_mov_b32 v3, 0
L_nonce:
    buffer_load_dword v4, v3, s[44:47], 0 offen sc1
    s_waitcnt vmcnt(0)
    v_readfirstlane_b32 s39, v4
    s_cmp_eq_u32 s39, 0
    s_cbranch_scc1 L_nonce
    v_mov_b32 v2, 159744
    s_mov_b64 exec, 1
    ds_write_b32 v2, v4 offset:100
    s_mov_b64 exec, -1
    s_branch L_h02
L_h0:
    s_cmp_ge_u32 s26, 28
    s_cbranch_scc1 L_fn
L_h02:
    s_setprio 0
    v_mov_b32 v160, 1073741824
    v_mov_b32 v161, 1073741824
    v_mov_b32 v162, 1073741824
    v_mov_b32 v163, 1073741824
    s_and_b32 s58, s2, 1
    s_bfe_u32 s60, s2, 0x20001
    s_lshr_b32 s27, s2, 3
    s_mul_i32 s28, s23, 28
    s_add_u32 s27, s27, s28
    s_mul_i32 s59, s27, 205
    s_lshr_b32 s59, s59, 10
    s_sub_u32 s60, s60, s59
    s_mul_i32 s60, s60, 5
    s_add_u32 s60, s60, s27
    s_add_u32 s28, s59, s58
    s_cmp_ge_u32 s28, 17
    s_cbranch_scc1 L_h03
    s_cmp_ge_u32 s60, 19
    s_cbranch_scc1 L_h03
    s_mov_b32 s62, 1
    s_cmp_eq_u32 s60, 18
    s_cselect_b32 s61, 1073741824, 0
    s_lshl_b32 s60, s60, 4
    s_add_u32 s60, s60, 1
    s_cmp_lg_u32 s61, 0
    s_cselect_b32 s60, 0, s60
    v_and_b32 v5, 15, v1
    v_lshrrev_b32 v6, 4, v1
    s_lshl_b32 s30, s59, 5
    s_add_u32 s30, s30, s58
    v_lshl_add_u32 v5, v5, 1, s30
    v_cvt_f32_u32 v24, v5
    v_mul_f32 v24, 0x3a000000, v24
    v_lshlrev_b32 v6, 4, v6
    v_cvt_f32_u32 v6, v6
    v_mul_f32 v26, 64.0, v24
    v_mul_f32 v25, v24, v6
    v_cos_f32 v26, v26
    v_cmp_gt_u32 vcc, 16, v1
    v_mov_b32 v28, 1.0
    v_add_f32 v26, v26, v26
    v_cndmask_b32 v28, v28, 0.5, vcc
    v_mov_b32 v8, v25
    v_fmamk_f32 v9, v24, 0x40000000, v25
    v_fmamk_f32 v10, v24, 0x40800000, v25
    v_fmamk_f32 v11, v24, 0x40c00000, v25
    v_fmamk_f32 v12, v24, 0x41000000, v25
    v_fmamk_f32 v13, v24, 0x41200000, v25
    v_fmamk_f32 v14, v24, 0x41400000, v25
    v_fmamk_f32 v15, v24, 0x41600000, v25
    v_cos_f32 v8, v8
    v_cos_f32 v9, v9
    v_cos_f32 v10, v10
    v_cos_f32 v11, v11
    v_cos_f32 v12, v12
    v_cos_f32 v13, v13
    v_cos_f32 v14, v14
    v_cos_f32 v15, v15
    v_fmamk_f32 v16, v24, 0x42800000, v25
    v_fmamk_f32 v17, v24, 0x42840000, v25
    v_fmamk_f32 v18, v24, 0x42880000, v25
    v_fmamk_f32 v19, v24, 0x428c0000, v25
    v_fmamk_f32 v20, v24, 0x42900000, v25
    v_fmamk_f32 v21, v24, 0x42940000, v25
    v_fmamk_f32 v22, v24, 0x42980000, v25
    v_fmamk_f32 v23, v24, 0x429c0000, v25
    v_cos_f32 v16, v16
    v_cos_f32 v17, v17
    v_cos_f32 v18, v18
    v_cos_f32 v19, v19
    v_cos_f32 v20, v20
    v_cos_f32 v21, v21
    v_cos_f32 v22, v22
    v_cos_f32 v23, v23
    v_mul_f32 v29, v28, v8
    v_cvt_pk_bf16_f32 v40, v29, v9
    v_cvt_pk_bf16_f32 v41, v10, v11
    v_cvt_pk_bf16_f32 v42, v12, v13
    v_cvt_pk_bf16_f32 v43, v14, v15
    v_cvt_pk_bf16_f32 v44, v16, v17
    v_cvt_pk_bf16_f32 v45, v18, v19
    v_cvt_pk_bf16_f32 v46, v20, v21
    v_cvt_pk_bf16_f32 v47, v22, v23
    v_pk_fma_f32 v[8:9], v[16:17], v[26:27], v[8:9] op_sel_hi:[1,0,1] neg_lo:[0,0,1] neg_hi:[0,0,1]
    v_pk_fma_f32 v[10:11], v[18:19], v[26:27], v[10:11] op_sel_hi:[1,0,1] neg_lo:[0,0,1] neg_hi:[0,0,1]
    v_pk_fma_f32 v[12:13], v[20:21], v[26:27], v[12:13] op_sel_hi:[1,0,1] neg_lo:[0,0,1] neg_hi:[0,0,1]
    v_pk_fma_f32 v[14:15], v[22:23], v[26:27], v[14:15] op_sel_hi:[1,0,1] neg_lo:[0,0,1] neg_hi:[0,0,1]
    v_cvt_pk_bf16_f32 v48, v8, v9
    v_cvt_pk_bf16_f32 v49, v10, v11
    v_cvt_pk_bf16_f32 v50, v12, v13
    v_cvt_pk_bf16_f32 v51, v14, v15
    v_pk_fma_f32 v[16:17], v[8:9], v[26:27], v[16:17] op_sel_hi:[1,0,1] neg_lo:[0,0,1] neg_hi:[0,0,1]
    v_pk_fma_f32 v[18:19], v[10:11], v[26:27], v[18:19] op_sel_hi:[1,0,1] neg_lo:[0,0,1] neg_hi:[0,0,1]
    v_pk_fma_f32 v[20:21], v[12:13], v[26:27], v[20:21] op_sel_hi:[1,0,1] neg_lo:[0,0,1] neg_hi:[0,0,1]
    v_pk_fma_f32 v[22:23], v[14:15], v[26:27], v[22:23] op_sel_hi:[1,0,1] neg_lo:[0,0,1] neg_hi:[0,0,1]
    v_cvt_pk_bf16_f32 v52, v16, v17
    v_cvt_pk_bf16_f32 v53, v18, v19
    v_cvt_pk_bf16_f32 v54, v20, v21
    v_cvt_pk_bf16_f32 v55, v22, v23
    v_pk_fma_f32 v[8:9], v[16:17], v[26:27], v[8:9] op_sel_hi:[1,0,1] neg_lo:[0,0,1] neg_hi:[0,0,1]
    v_pk_fma_f32 v[10:11], v[18:19], v[26:27], v[10:11] op_sel_hi:[1,0,1] neg_lo:[0,0,1] neg_hi:[0,0,1]
    v_pk_fma_f32 v[12:13], v[20:21], v[26:27], v[12:13] op_sel_hi:[1,0,1] neg_lo:[0,0,1] neg_hi:[0,0,1]
    v_pk_fma_f32 v[14:15], v[22:23], v[26:27], v[14:15] op_sel_hi:[1,0,1] neg_lo:[0,0,1] neg_hi:[0,0,1]
    v_cvt_pk_bf16_f32 v56, v8, v9
    v_cvt_pk_bf16_f32 v57, v10, v11
    v_cvt_pk_bf16_f32 v58, v12, v13
    v_cvt_pk_bf16_f32 v59, v14, v15
    v_pk_fma_f32 v[16:17], v[8:9], v[26:27], v[16:17] op_sel_hi:[1,0,1] neg_lo:[0,0,1] neg_hi:[0,0,1]
    v_pk_fma_f32 v[18:19], v[10:11], v[26:27], v[18:19] op_sel_hi:[1,0,1] neg_lo:[0,0,1] neg_hi:[0,0,1]
    v_pk_fma_f32 v[20:21], v[12:13], v[26:27], v[20:21] op_sel_hi:[1,0,1] neg_lo:[0,0,1] neg_hi:[0,0,1]
    v_pk_fma_f32 v[22:23], v[14:15], v[26:27], v[22:23] op_sel_hi:[1,0,1] neg_lo:[0,0,1] neg_hi:[0,0,1]
    v_cvt_pk_bf16_f32 v60, v16, v17
    v_cvt_pk_bf16_f32 v61, v18, v19
    v_cvt_pk_bf16_f32 v62, v20, v21
    v_cvt_pk_bf16_f32 v63, v22, v23
    v_pk_fma_f32 v[8:9], v[16:17], v[26:27], v[8:9] op_sel_hi:[1,0,1] neg_lo:[0,0,1] neg_hi:[0,0,1]
    v_pk_fma_f32 v[10:11], v[18:19], v[26:27], v[10:11] op_sel_hi:[1,0,1] neg_lo:[0,0,1] neg_hi:[0,0,1]
    v_pk_fma_f32 v[12:13], v[20:21], v[26:27], v[12:13] op_sel_hi:[1,0,1] neg_lo:[0,0,1] neg_hi:[0,0,1]
    v_pk_fma_f32 v[14:15], v[22:23], v[26:27], v[14:15] op_sel_hi:[1,0,1] neg_lo:[0,0,1] neg_hi:[0,0,1]
    v_cvt_pk_bf16_f32 v64, v8, v9
    v_cvt_pk_bf16_f32 v65, v10, v11
    v_cvt_pk_bf16_f32 v66, v12, v13
    v_cvt_pk_bf16_f32 v67, v14, v15
    v_pk_fma_f32 v[16:17], v[8:9], v[26:27], v[16:17] op_sel_hi:[1,0,1] neg_lo:[0,0,1] neg_hi:[0,0,1]
    v_pk_fma_f32 v[18:19], v[10:11], v[26:27], v[18:19] op_sel_hi:[1,0,1] neg_lo:[0,0,1] neg_hi:[0,0,1]
    v_pk_fma_f32 v[20:21], v[12:13], v[26:27], v[20:21] op_sel_hi:[1,0,1] neg_lo:[0,0,1] neg_hi:[0,0,1]
    v_pk_fma_f32 v[22:23], v[14:15], v[26:27], v[22:23] op_sel_hi:[1,0,1] neg_lo:[0,0,1] neg_hi:[0,0,1]
    v_cvt_pk_bf16_f32 v68, v16, v17
    v_cvt_pk_bf16_f32 v69, v18, v19
    v_cvt_pk_bf16_f32 v70, v20, v21
    v_cvt_pk_bf16_f32 v71, v22, v23
    v_add_f32 v25, v25, v24
    v_mov_b32 v8, v25
    v_fmamk_f32 v9, v24, 0x40000000, v25
    v_fmamk_f32 v10, v24, 0x40800000, v25
    v_fmamk_f32 v11, v24, 0x40c00000, v25
    v_fmamk_f32 v12, v24, 0x41000000, v25
    v_fmamk_f32 v13, v24, 0x41200000, v25
    v_fmamk_f32 v14, v24, 0x41400000, v25
    v_fmamk_f32 v15, v24, 0x41600000, v25
    v_cos_f32 v8, v8
    v_cos_f32 v9, v9
    v_cos_f32 v10, v10
    v_cos_f32 v11, v11
    v_cos_f32 v12, v12
    v_cos_f32 v13, v13
    v_cos_f32 v14, v14
    v_cos_f32 v15, v15
    v_fmamk_f32 v16, v24, 0x42800000, v25
    v_fmamk_f32 v17, v24, 0x42840000, v25
    v_fmamk_f32 v18, v24, 0x42880000, v25
    v_fmamk_f32 v19, v24, 0x428c0000, v25
    v_fmamk_f32 v20, v24, 0x42900000, v25
    v_fmamk_f32 v21, v24, 0x42940000, v25
    v_fmamk_f32 v22, v24, 0x42980000, v25
    v_fmamk_f32 v23, v24, 0x429c0000, v25
    v_cos_f32 v16, v16
    v_cos_f32 v17, v17
    v_cos_f32 v18, v18
    v_cos_f32 v19, v19
    v_cos_f32 v20, v20
    v_cos_f32 v21, v21
    v_cos_f32 v22, v22
    v_cos_f32 v23, v23
    v_cvt_pk_bf16_f32 v72, v8, v9
    v_cvt_pk_bf16_f32 v73, v10, v11
    v_cvt_pk_bf16_f32 v74, v12, v13
    v_cvt_pk_bf16_f32 v75, v14, v15
    v_cvt_pk_bf16_f32 v76, v16, v17
    v_cvt_pk_bf16_f32 v77, v18, v19
    v_cvt_pk_bf16_f32 v78, v20, v21
    v_cvt_pk_bf16_f32 v79, v22, v23
    v_pk_fma_f32 v[8:9], v[16:17], v[26:27], v[8:9] op_sel_hi:[1,0,1] neg_lo:[0,0,1] neg_hi:[0,0,1]
    v_pk_fma_f32 v[10:11], v[18:19], v[26:27], v[10:11] op_sel_hi:[1,0,1] neg_lo:[0,0,1] neg_hi:[0,0,1]
    v_pk_fma_f32 v[12:13], v[20:21], v[26:27], v[12:13] op_sel_hi:[1,0,1] neg_lo:[0,0,1] neg_hi:[0,0,1]
    v_pk_fma_f32 v[14:15], v[22:23], v[26:27], v[14:15] op_sel_hi:[1,0,1] neg_lo:[0,0,1] neg_hi:[0,0,1]
    v_cvt_pk_bf16_f32 v80, v8, v9
    v_cvt_pk_bf16_f32 v81, v10, v11
    v_cvt_pk_bf16_f32 v82, v12, v13
    v_cvt_pk_bf16_f32 v83, v14, v15
    v_pk_fma_f32 v[16:17], v[8:9], v[26:27], v[16:17] op_sel_hi:[1,0,1] neg_lo:[0,0,1] neg_hi:[0,0,1]
    v_pk_fma_f32 v[18:19], v[10:11], v[26:27], v[18:19] op_sel_hi:[1,0,1] neg_lo:[0,0,1] neg_hi:[0,0,1]
    v_pk_fma_f32 v[20:21], v[12:13], v[26:27], v[20:21] op_sel_hi:[1,0,1] neg_lo:[0,0,1] neg_hi:[0,0,1]
    v_pk_fma_f32 v[22:23], v[14:15], v[26:27], v[22:23] op_sel_hi:[1,0,1] neg_lo:[0,0,1] neg_hi:[0,0,1]
    v_cvt_pk_bf16_f32 v84, v16, v17
    v_cvt_pk_bf16_f32 v85, v18, v19
    v_cvt_pk_bf16_f32 v86, v20, v21
    v_cvt_pk_bf16_f32 v87, v22, v23
    v_pk_fma_f32 v[8:9], v[16:17], v[26:27], v[8:9] op_sel_hi:[1,0,1] neg_lo:[0,0,1] neg_hi:[0,0,1]
    v_pk_fma_f32 v[10:11], v[18:19], v[26:27], v[10:11] op_sel_hi:[1,0,1] neg_lo:[0,0,1] neg_hi:[0,0,1]
    v_pk_fma_f32 v[12:13], v[20:21], v[26:27], v[12:13] op_sel_hi:[1,0,1] neg_lo:[0,0,1] neg_hi:[0,0,1]
    v_pk_fma_f32 v[14:15], v[22:23], v[26:27], v[14:15] op_sel_hi:[1,0,1] neg_lo:[0,0,1] neg_hi:[0,0,1]
    v_cvt_pk_bf16_f32 v88, v8, v9
    v_cvt_pk_bf16_f32 v89, v10, v11
    v_cvt_pk_bf16_f32 v90, v12, v13
    v_cvt_pk_bf16_f32 v91, v14, v15
    v_pk_fma_f32 v[16:17], v[8:9], v[26:27], v[16:17] op_sel_hi:[1,0,1] neg_lo:[0,0,1] neg_hi:[0,0,1]
    v_pk_fma_f32 v[18:19], v[10:11], v[26:27], v[18:19] op_sel_hi:[1,0,1] neg_lo:[0,0,1] neg_hi:[0,0,1]
    v_pk_fma_f32 v[20:21], v[12:13], v[26:27], v[20:21] op_sel_hi:[1,0,1] neg_lo:[0,0,1] neg_hi:[0,0,1]
    v_pk_fma_f32 v[22:23], v[14:15], v[26:27], v[22:23] op_sel_hi:[1,0,1] neg_lo:[0,0,1] neg_hi:[0,0,1]
    v_cvt_pk_bf16_f32 v92, v16, v17
    v_cvt_pk_bf16_f32 v93, v18, v19
    v_cvt_pk_bf16_f32 v94, v20, v21
    v_cvt_pk_bf16_f32 v95, v22, v23
    v_pk_fma_f32 v[8:9], v[16:17], v[26:27], v[8:9] op_sel_hi:[1,0,1] neg_lo:[0,0,1] neg_hi:[0,0,1]
    v_pk_fma_f32 v[10:11], v[18:19], v[26:27], v[10:11] op_sel_hi:[1,0,1] neg_lo:[0,0,1] neg_hi:[0,0,1]
    v_pk_fma_f32 v[12:13], v[20:21], v[26:27], v[12:13] op_sel_hi:[1,0,1] neg_lo:[0,0,1] neg_hi:[0,0,1]
    v_pk_fma_f32 v[14:15], v[22:23], v[26:27], v[14:15] op_sel_hi:[1,0,1] neg_lo:[0,0,1] neg_hi:[0,0,1]
    v_cvt_pk_bf16_f32 v96, v8, v9
    v_cvt_pk_bf16_f32 v97, v10, v11
    v_cvt_pk_bf16_f32 v98, v12, v13
    v_cvt_pk_bf16_f32 v99, v14, v15
    v_pk_fma_f32 v[16:17], v[8:9], v[26:27], v[16:17] op_sel_hi:[1,0,1] neg_lo:[0,0,1] neg_hi:[0,0,1]
    v_pk_fma_f32 v[18:19], v[10:11], v[26:27], v[18:19] op_sel_hi:[1,0,1] neg_lo:[0,0,1] neg_hi:[0,0,1]
    v_pk_fma_f32 v[20:21], v[12:13], v[26:27], v[20:21] op_sel_hi:[1,0,1] neg_lo:[0,0,1] neg_hi:[0,0,1]
    v_pk_fma_f32 v[22:23], v[14:15], v[26:27], v[22:23] op_sel_hi:[1,0,1] neg_lo:[0,0,1] neg_hi:[0,0,1]
    v_cvt_pk_bf16_f32 v100, v16, v17
    v_cvt_pk_bf16_f32 v101, v18, v19
    v_cvt_pk_bf16_f32 v102, v20, v21
    v_cvt_pk_bf16_f32 v103, v22, v23
    v_sub_f32 v25, v25, v24
    v_add_f32 v25, 0xbe800000, v25
    v_mov_b32 v8, v25
    v_fmamk_f32 v9, v24, 0x40000000, v25
    v_fmamk_f32 v10, v24, 0x40800000, v25
    v_fmamk_f32 v11, v24, 0x40c00000, v25
    v_fmamk_f32 v12, v24, 0x41000000, v25
    v_fmamk_f32 v13, v24, 0x41200000, v25
    v_fmamk_f32 v14, v24, 0x41400000, v25
    v_fmamk_f32 v15, v24, 0x41600000, v25
    v_cos_f32 v8, v8
    v_cos_f32 v9, v9
    v_cos_f32 v10, v10
    v_cos_f32 v11, v11
    v_cos_f32 v12, v12
    v_cos_f32 v13, v13
    v_cos_f32 v14, v14
    v_cos_f32 v15, v15
    v_fmamk_f32 v16, v24, 0x42800000, v25
    v_fmamk_f32 v17, v24, 0x42840000, v25
    v_fmamk_f32 v18, v24, 0x42880000, v25
    v_fmamk_f32 v19, v24, 0x428c0000, v25
    v_fmamk_f32 v20, v24, 0x42900000, v25
    v_fmamk_f32 v21, v24, 0x42940000, v25
    v_fmamk_f32 v22, v24, 0x42980000, v25
    v_fmamk_f32 v23, v24, 0x429c0000, v25
    v_cos_f32 v16, v16
    v_cos_f32 v17, v17
    v_cos_f32 v18, v18
    v_cos_f32 v19, v19
    v_cos_f32 v20, v20
    v_cos_f32 v21, v21
    v_cos_f32 v22, v22
    v_cos_f32 v23, v23
    v_cvt_pk_bf16_f32 v104, v8, v9
    v_cvt_pk_bf16_f32 v105, v10, v11
    v_cvt_pk_bf16_f32 v106, v12, v13
    v_cvt_pk_bf16_f32 v107, v14, v15
    v_cvt_pk_bf16_f32 v108, v16, v17
    v_cvt_pk_bf16_f32 v109, v18, v19
    v_cvt_pk_bf16_f32 v110, v20, v21
    v_cvt_pk_bf16_f32 v111, v22, v23
    v_pk_fma_f32 v[8:9], v[16:17], v[26:27], v[8:9] op_sel_hi:[1,0,1] neg_lo:[0,0,1] neg_hi:[0,0,1]
    v_pk_fma_f32 v[10:11], v[18:19], v[26:27], v[10:11] op_sel_hi:[1,0,1] neg_lo:[0,0,1] neg_hi:[0,0,1]
    v_pk_fma_f32 v[12:13], v[20:21], v[26:27], v[12:13] op_sel_hi:[1,0,1] neg_lo:[0,0,1] neg_hi:[0,0,1]
    v_pk_fma_f32 v[14:15], v[22:23], v[26:27], v[14:15] op_sel_hi:[1,0,1] neg_lo:[0,0,1] neg_hi:[0,0,1]
    v_cvt_pk_bf16_f32 v112, v8, v9
    v_cvt_pk_bf16_f32 v113, v10, v11
    v_cvt_pk_bf16_f32 v114, v12, v13
    v_cvt_pk_bf16_f32 v115, v14, v15
    v_pk_fma_f32 v[16:17], v[8:9], v[26:27], v[16:17] op_sel_hi:[1,0,1] neg_lo:[0,0,1] neg_hi:[0,0,1]
    v_pk_fma_f32 v[18:19], v[10:11], v[26:27], v[18:19] op_sel_hi:[1,0,1] neg_lo:[0,0,1] neg_hi:[0,0,1]
    v_pk_fma_f32 v[20:21], v[12:13], v[26:27], v[20:21] op_sel_hi:[1,0,1] neg_lo:[0,0,1] neg_hi:[0,0,1]
    v_pk_fma_f32 v[22:23], v[14:15], v[26:27], v[22:23] op_sel_hi:[1,0,1] neg_lo:[0,0,1] neg_hi:[0,0,1]
    v_cvt_pk_bf16_f32 v116, v16, v17
    v_cvt_pk_bf16_f32 v117, v18, v19
    v_cvt_pk_bf16_f32 v118, v20, v21
    v_cvt_pk_bf16_f32 v119, v22, v23
    v_pk_fma_f32 v[8:9], v[16:17], v[26:27], v[8:9] op_sel_hi:[1,0,1] neg_lo:[0,0,1] neg_hi:[0,0,1]
    v_pk_fma_f32 v[10:11], v[18:19], v[26:27], v[10:11] op_sel_hi:[1,0,1] neg_lo:[0,0,1] neg_hi:[0,0,1]
    v_pk_fma_f32 v[12:13], v[20:21], v[26:27], v[12:13] op_sel_hi:[1,0,1] neg_lo:[0,0,1] neg_hi:[0,0,1]
    v_pk_fma_f32 v[14:15], v[22:23], v[26:27], v[14:15] op_sel_hi:[1,0,1] neg_lo:[0,0,1] neg_hi:[0,0,1]
    v_cvt_pk_bf16_f32 v120, v8, v9
    v_cvt_pk_bf16_f32 v121, v10, v11
    v_cvt_pk_bf16_f32 v122, v12, v13
    v_cvt_pk_bf16_f32 v123, v14, v15
    v_pk_fma_f32 v[16:17], v[8:9], v[26:27], v[16:17] op_sel_hi:[1,0,1] neg_lo:[0,0,1] neg_hi:[0,0,1]
    v_pk_fma_f32 v[18:19], v[10:11], v[26:27], v[18:19] op_sel_hi:[1,0,1] neg_lo:[0,0,1] neg_hi:[0,0,1]
    v_pk_fma_f32 v[20:21], v[12:13], v[26:27], v[20:21] op_sel_hi:[1,0,1] neg_lo:[0,0,1] neg_hi:[0,0,1]
    v_pk_fma_f32 v[22:23], v[14:15], v[26:27], v[22:23] op_sel_hi:[1,0,1] neg_lo:[0,0,1] neg_hi:[0,0,1]
    v_cvt_pk_bf16_f32 v124, v16, v17
    v_cvt_pk_bf16_f32 v125, v18, v19
    v_cvt_pk_bf16_f32 v126, v20, v21
    v_cvt_pk_bf16_f32 v127, v22, v23
    v_pk_fma_f32 v[8:9], v[16:17], v[26:27], v[8:9] op_sel_hi:[1,0,1] neg_lo:[0,0,1] neg_hi:[0,0,1]
    v_pk_fma_f32 v[10:11], v[18:19], v[26:27], v[10:11] op_sel_hi:[1,0,1] neg_lo:[0,0,1] neg_hi:[0,0,1]
    v_pk_fma_f32 v[12:13], v[20:21], v[26:27], v[12:13] op_sel_hi:[1,0,1] neg_lo:[0,0,1] neg_hi:[0,0,1]
    v_pk_fma_f32 v[14:15], v[22:23], v[26:27], v[14:15] op_sel_hi:[1,0,1] neg_lo:[0,0,1] neg_hi:[0,0,1]
    v_cvt_pk_bf16_f32 v128, v8, v9
    v_cvt_pk_bf16_f32 v129, v10, v11
    v_cvt_pk_bf16_f32 v130, v12, v13
    v_cvt_pk_bf16_f32 v131, v14, v15
    v_pk_fma_f32 v[16:17], v[8:9], v[26:27], v[16:17] op_sel_hi:[1,0,1] neg_lo:[0,0,1] neg_hi:[0,0,1]
    v_pk_fma_f32 v[18:19], v[10:11], v[26:27], v[18:19] op_sel_hi:[1,0,1] neg_lo:[0,0,1] neg_hi:[0,0,1]
    v_pk_fma_f32 v[20:21], v[12:13], v[26:27], v[20:21] op_sel_hi:[1,0,1] neg_lo:[0,0,1] neg_hi:[0,0,1]
    v_pk_fma_f32 v[22:23], v[14:15], v[26:27], v[22:23] op_sel_hi:[1,0,1] neg_lo:[0,0,1] neg_hi:[0,0,1]
    v_cvt_pk_bf16_f32 v132, v16, v17
    v_cvt_pk_bf16_f32 v133, v18, v19
    v_cvt_pk_bf16_f32 v134, v20, v21
    v_cvt_pk_bf16_f32 v135, v22, v23
    v_add_f32 v25, v25, v24
    v_mov_b32 v8, v25
    v_fmamk_f32 v9, v24, 0x40000000, v25
    v_fmamk_f32 v10, v24, 0x40800000, v25
    v_fmamk_f32 v11, v24, 0x40c00000, v25
    v_fmamk_f32 v12, v24, 0x41000000, v25
    v_fmamk_f32 v13, v24, 0x41200000, v25
    v_fmamk_f32 v14, v24, 0x41400000, v25
    v_fmamk_f32 v15, v24, 0x41600000, v25
    v_cos_f32 v8, v8
    v_cos_f32 v9, v9
    v_cos_f32 v10, v10
    v_cos_f32 v11, v11
    v_cos_f32 v12, v12
    v_cos_f32 v13, v13
    v_cos_f32 v14, v14
    v_cos_f32 v15, v15
    v_fmamk_f32 v16, v24, 0x42800000, v25
    v_fmamk_f32 v17, v24, 0x42840000, v25
    v_fmamk_f32 v18, v24, 0x42880000, v25
    v_fmamk_f32 v19, v24, 0x428c0000, v25
    v_fmamk_f32 v20, v24, 0x42900000, v25
    v_fmamk_f32 v21, v24, 0x42940000, v25
    v_fmamk_f32 v22, v24, 0x42980000, v25
    v_fmamk_f32 v23, v24, 0x429c0000, v25
    v_cos_f32 v16, v16
    v_cos_f32 v17, v17
    v_cos_f32 v18, v18
    v_cos_f32 v19, v19
    v_cos_f32 v20, v20
    v_cos_f32 v21, v21
    v_cos_f32 v22, v22
    v_cos_f32 v23, v23
    v_cvt_pk_bf16_f32 v136, v8, v9
    v_cvt_pk_bf16_f32 v137, v10, v11
    v_cvt_pk_bf16_f32 v138, v12, v13
    v_cvt_pk_bf16_f32 v139, v14, v15
    v_cvt_pk_bf16_f32 v140, v16, v17
    v_cvt_pk_bf16_f32 v141, v18, v19
    v_cvt_pk_bf16_f32 v142, v20, v21
    v_cvt_pk_bf16_f32 v143, v22, v23
    v_pk_fma_f32 v[8:9], v[16:17], v[26:27], v[8:9] op_sel_hi:[1,0,1] neg_lo:[0,0,1] neg_hi:[0,0,1]
    v_pk_fma_f32 v[10:11], v[18:19], v[26:27], v[10:11] op_sel_hi:[1,0,1] neg_lo:[0,0,1] neg_hi:[0,0,1]
    v_pk_fma_f32 v[12:13], v[20:21], v[26:27], v[12:13] op_sel_hi:[1,0,1] neg_lo:[0,0,1] neg_hi:[0,0,1]
    v_pk_fma_f32 v[14:15], v[22:23], v[26:27], v[14:15] op_sel_hi:[1,0,1] neg_lo:[0,0,1] neg_hi:[0,0,1]
    v_cvt_pk_bf16_f32 v144, v8, v9
    v_cvt_pk_bf16_f32 v145, v10, v11
    v_cvt_pk_bf16_f32 v146, v12, v13
    v_cvt_pk_bf16_f32 v147, v14, v15
    v_pk_fma_f32 v[16:17], v[8:9], v[26:27], v[16:17] op_sel_hi:[1,0,1] neg_lo:[0,0,1] neg_hi:[0,0,1]
    v_pk_fma_f32 v[18:19], v[10:11], v[26:27], v[18:19] op_sel_hi:[1,0,1] neg_lo:[0,0,1] neg_hi:[0,0,1]
    v_pk_fma_f32 v[20:21], v[12:13], v[26:27], v[20:21] op_sel_hi:[1,0,1] neg_lo:[0,0,1] neg_hi:[0,0,1]
    v_pk_fma_f32 v[22:23], v[14:15], v[26:27], v[22:23] op_sel_hi:[1,0,1] neg_lo:[0,0,1] neg_hi:[0,0,1]
    v_cvt_pk_bf16_f32 v148, v16, v17
    v_cvt_pk_bf16_f32 v149, v18, v19
    v_cvt_pk_bf16_f32 v150, v20, v21
    v_cvt_pk_bf16_f32 v151, v22, v23
    v_pk_fma_f32 v[8:9], v[16:17], v[26:27], v[8:9] op_sel_hi:[1,0,1] neg_lo:[0,0,1] neg_hi:[0,0,1]
    v_pk_fma_f32 v[10:11], v[18:19], v[26:27], v[10:11] op_sel_hi:[1,0,1] neg_lo:[0,0,1] neg_hi:[0,0,1]
    v_pk_fma_f32 v[12:13], v[20:21], v[26:27], v[12:13] op_sel_hi:[1,0,1] neg_lo:[0,0,1] neg_hi:[0,0,1]
    v_pk_fma_f32 v[14:15], v[22:23], v[26:27], v[14:15] op_sel_hi:[1,0,1] neg_lo:[0,0,1] neg_hi:[0,0,1]
    v_cvt_pk_bf16_f32 v152, v8, v9
    v_cvt_pk_bf16_f32 v153, v10, v11
    v_cvt_pk_bf16_f32 v154, v12, v13
    v_cvt_pk_bf16_f32 v155, v14, v15
    v_pk_fma_f32 v[16:17], v[8:9], v[26:27], v[16:17] op_sel_hi:[1,0,1] neg_lo:[0,0,1] neg_hi:[0,0,1]
    v_pk_fma_f32 v[18:19], v[10:11], v[26:27], v[18:19] op_sel_hi:[1,0,1] neg_lo:[0,0,1] neg_hi:[0,0,1]
    v_pk_fma_f32 v[20:21], v[12:13], v[26:27], v[20:21] op_sel_hi:[1,0,1] neg_lo:[0,0,1] neg_hi:[0,0,1]
    v_pk_fma_f32 v[22:23], v[14:15], v[26:27], v[22:23] op_sel_hi:[1,0,1] neg_lo:[0,0,1] neg_hi:[0,0,1]
    v_cvt_pk_bf16_f32 v156, v16, v17
    v_cvt_pk_bf16_f32 v157, v18, v19
    v_cvt_pk_bf16_f32 v158, v20, v21
    v_cvt_pk_bf16_f32 v159, v22, v23
    v_pk_fma_f32 v[8:9], v[16:17], v[26:27], v[8:9] op_sel_hi:[1,0,1] neg_lo:[0,0,1] neg_hi:[0,0,1]
    v_pk_fma_f32 v[10:11], v[18:19], v[26:27], v[10:11] op_sel_hi:[1,0,1] neg_lo:[0,0,1] neg_hi:[0,0,1]
    v_pk_fma_f32 v[12:13], v[20:21], v[26:27], v[12:13] op_sel_hi:[1,0,1] neg_lo:[0,0,1] neg_hi:[0,0,1]
    v_pk_fma_f32 v[14:15], v[22:23], v[26:27], v[14:15] op_sel_hi:[1,0,1] neg_lo:[0,0,1] neg_hi:[0,0,1]
    v_cvt_pk_bf16_f32 v160, v8, v9
    v_cvt_pk_bf16_f32 v161, v10, v11
    v_cvt_pk_bf16_f32 v162, v12, v13
    v_cvt_pk_bf16_f32 v163, v14, v15
    v_pk_fma_f32 v[16:17], v[8:9], v[26:27], v[16:17] op_sel_hi:[1,0,1] neg_lo:[0,0,1] neg_hi:[0,0,1]
    v_pk_fma_f32 v[18:19], v[10:11], v[26:27], v[18:19] op_sel_hi:[1,0,1] neg_lo:[0,0,1] neg_hi:[0,0,1]
    v_pk_fma_f32 v[20:21], v[12:13], v[26:27], v[20:21] op_sel_hi:[1,0,1] neg_lo:[0,0,1] neg_hi:[0,0,1]
    v_pk_fma_f32 v[22:23], v[14:15], v[26:27], v[22:23] op_sel_hi:[1,0,1] neg_lo:[0,0,1] neg_hi:[0,0,1]
    v_cvt_pk_bf16_f32 v164, v16, v17
    v_cvt_pk_bf16_f32 v165, v18, v19
    v_cvt_pk_bf16_f32 v166, v20, v21
    v_cvt_pk_bf16_f32 v167, v22, v23
L_h03:
    v_mov_b32 v3, 196608
    s_mov_b32 s27, 159744
    v_mov_b32 v4, 1
    v_writelane_b32 v3, s27, 0
L_h_n:
    ds_read_b32 v5, v3 offset:100
    s_waitcnt lgkmcnt(0)
    v_readfirstlane_b32 s39, v5
    s_cmp_eq_u32 s39, 0
    s_cbranch_scc1 L_h_n
L_h1:
    s_setprio 2
    s_mul_i32 s26, s21, 18
    s_and_b32 s27, s21, 1
    s_lshl_b32 s27, s27, 1
    s_sub_u32 s26, s26, s27
    s_add_u32 s27, s26, 595
    s_add_u32 s26, s26, 576
    s_lshr_b32 s26, s26, 6
    s_lshr_b32 s27, s27, 6
    s_mul_i32 s28, s21, 18
    s_add_u32 s29, s28, 1169
    s_add_u32 s28, s28, 1152
    s_lshr_b32 s28, s28, 6
    s_lshr_b32 s29, s29, 6
    v_mov_b32 v6, s26
    v_writelane_b32 v6, s27, 1
    v_writelane_b32 v6, s28, 2
    v_writelane_b32 v6, s29, 3
    v_writelane_b32 v6, s27, 5
    v_writelane_b32 v6, s28, 6
    v_writelane_b32 v6, s29, 7
    s_lshl_b32 s29, s23, 9
    s_add_u32 s29, s29, 13631488
    v_lshrrev_b32 v7, 2, v1
    v_lshl_add_u32 v6, v6, 5, v7
    v_lshlrev_b32 v6, 8, v6
    s_add_u32 s24, s21, 32
    s_mul_i32 s24, s24, 69888
    s_lshl_b32 s25, s23, 12
    s_add_u32 s24, s24, s25
    s_lshr_b32 s26, s21, 1
    s_add_u32 s26, s26, 16
    s_lshl_b32 s26, s26, 14
    s_lshl_b32 s25, s23, 10
    s_add_u32 s26, s26, s25
    s_add_u32 s26, s26, 9437184
    s_mul_i32 s32, s21, 288
    s_mul_i32 s25, s23, 147456
    s_add_u32 s32, s32, s25
    s_add_u32 s32, s32, 5242880
    v_lshlrev_b32 v2, 4, v1
    s_lshl_b32 s31, s23, 6
    v_add_u32 v7, s31, v1
    v_mul_u32_u24 v13, 304, v7
    v_add_u32 v13, 65824, v13
    v_mov_b32 v7, v1
    v_mul_u32_u24 v5, 3450, v7
    v_lshrrev_b32 v5, 16, v5
    v_mul_u32_u24 v14, 19, v5
    v_sub_u32 v14, v7, v14
    v_cmp_ne_u32 s[48:49], 18, v14
    v_mul_u32_u24 v5, 9216, v5
    v_lshl_add_u32 v8, v14, 4, v5
    v_add_u32 v7, 64, v7
    v_mul_u32_u24 v5, 3450, v7
    v_lshrrev_b32 v5, 16, v5
    v_mul_u32_u24 v14, 19, v5
    v_sub_u32 v14, v7, v14
    v_cmp_ne_u32 s[50:51], 18, v14
    v_mul_u32_u24 v5, 9216, v5
    v_lshl_add_u32 v9, v14, 4, v5
    v_add_u32 v7, 64, v7
    v_mul_u32_u24 v5, 3450, v7
    v_lshrrev_b32 v5, 16, v5
    v_mul_u32_u24 v14, 19, v5
    v_sub_u32 v14, v7, v14
    v_cmp_ne_u32 s[52:53], 18, v14
    v_mul_u32_u24 v5, 9216, v5
    v_lshl_add_u32 v10, v14, 4, v5
    v_add_u32 v7, 64, v7
    v_mul_u32_u24 v5, 3450, v7
    v_lshrrev_b32 v5, 16, v5
    v_mul_u32_u24 v14, 19, v5
    v_sub_u32 v14, v7, v14
    v_cmp_ne_u32 s[54:55], 18, v14
    v_mul_u32_u24 v5, 9216, v5
    v_lshl_add_u32 v11, v14, 4, v5
    v_add_u32 v7, 64, v7
    v_mul_u32_u24 v5, 3450, v7
    v_lshrrev_b32 v5, 16, v5
    v_mul_u32_u24 v14, 19, v5
    v_sub_u32 v14, v7, v14
    v_cmp_ne_u32 s[56:57], 18, v14
    v_mul_u32_u24 v5, 9216, v5
    v_lshl_add_u32 v12, v14, 4, v5
    v_add_u32 v7, 64, v7
    v_mov_b32 v16, 0x3f803f80
    v_mov_b32 v17, 0x3f803f80
    v_mov_b32 v18, 0x3f803f80
    v_mov_b32 v19, 0x3f803f80
    s_and_b32 s57, s57, 0xffff
    s_mov_b32 s34, 0
L_p2_fr:
    ds_read_b32 v5, v3 offset:80
    s_waitcnt lgkmcnt(0)
    v_readfirstlane_b32 s30, v5
    s_cmp_ge_u32 s30, 4
    s_cbranch_scc1 L_p2_fr_ok
    s_sleep 4
    s_branch L_p2_fr
L_p2_fr_ok:
    v_lshlrev_b32 v5, 9, v1
    v_add_u32 v5, 160768, v5
    s_mov_b64 exec, 31
    ds_write_b128 v5, v[16:19]
    s_mov_b64 exec, -1
    ds_write_b128 v13, v[16:19]
    ds_add_u32 v3, v4 offset:164
    s_sleep 40
L_kp:
    s_mov_b64 exec, 0xff
    buffer_load_dword v14, v6, s[8:11], s29 offen sc1
    s_waitcnt vmcnt(0)
    v_cmp_ne_u32 vcc, s39, v14
    s_mov_b64 exec, -1
    s_cbranch_vccz L_kp_s
    s_cmp_eq_u32 s34, 0
    s_cbranch_scc1 L_kp_0
    s_sleep 4
L_kp_0:
    s_sleep 2
    s_branch L_kp
L_kp_s:
    ds_add_rtn_u32 v5, v3, v4 offset:160
    s_waitcnt lgkmcnt(0)
    v_readfirstlane_b32 s35, v5
    s_lshl_b32 s27, s35, 10
    s_add_u32 m0, s27, 143360
    s_lshl_b32 s27, s35, 12
    buffer_load_dwordx4 v2, s[8:11], s26 offen sc1 lds
    s_add_u32 m0, s27, 0
    s_add_u32 s33, s24, 0
    buffer_load_dwordx4 v2, s[8:11], s33 offen sc1 lds
    s_add_u32 m0, s27, 1024
    s_add_u32 s33, s24, 1024
    buffer_load_dwordx4 v2, s[8:11], s33 offen sc1 lds
    s_add_u32 m0, s27, 2048
    s_add_u32 s33, s24, 2048
    buffer_load_dwordx4 v2, s[8:11], s33 offen sc1 lds
    s_add_u32 m0, s27, 3072
    s_add_u32 s33, s24, 3072
    buffer_load_dwordx4 v2, s[8:11], s33 offen sc1 lds
    s_mul_i32 s27, s35, 4864
    s_add_u32 m0, s27, 65536
    s_mov_b64 exec, s[48:49]
    buffer_load_dwordx4 v8, s[8:11], s32 offen sc1 lds
    s_add_u32 m0, s27, 66560
    s_mov_b64 exec, s[50:51]
    buffer_load_dwordx4 v9, s[8:11], s32 offen sc1 lds
    s_add_u32 m0, s27, 67584
    s_mov_b64 exec, s[52:53]
    buffer_load_dwordx4 v10, s[8:11], s32 offen sc1 lds
    s_add_u32 m0, s27, 68608
    s_mov_b64 exec, s[54:55]
    buffer_load_dwordx4 v11, s[8:11], s32 offen sc1 lds
    s_add_u32 m0, s27, 69632
    s_mov_b64 exec, s[56:57]
    buffer_load_dwordx4 v12, s[8:11], s32 offen sc1 lds
    s_mov_b64 exec, -1
    s_lshl_b32 s35, 1, s35
    v_mov_b32 v5, s35
    s_add_u32 s24, s24, 16384
    s_add_u32 s26, s26, 4096
    s_add_u32 s32, s32, 589824
    s_add_u32 s29, s29, 2048
    s_add_u32 s34, s34, 1
    s_waitcnt vmcnt(0)
    ds_or_b32 v3, v5 offset:104
    s_add_u32 s31, s34, 1
    s_cmp_lg_u32 s63, s31
    s_cbranch_scc1 L_hl2_f
    s_waitcnt vmcnt(0)
    s_cmp_eq_u32 s60, 0
    s_cbranch_scc1 L_hl2_d
    ds_add_rtn_u32 v5, v3, v4 offset:96
    s_waitcnt lgkmcnt(0)
    v_readfirstlane_b32 s30, v5
    s_cmp_lg_u32 s30, s60
    s_cbranch_scc1 L_hl2_f
L_hl2_d:
    v_mov_b32 v5, s39
    s_mov_b64 exec, 1
    buffer_store_dword v5, off, s[8:11], s61 sc1
    s_mov_b64 exec, -1
L_hl2_f:
    s_add_u32 s31, s34, 2
    s_cmp_lg_u32 s63, s31
    s_cbranch_scc1 L_hl1_s
    buffer_store_dwordx4 v[128:131], v160, s[8:11], 0 offen sc1
    buffer_store_dwordx4 v[132:135], v161, s[8:11], 0 offen sc1
    buffer_store_dwordx4 v[136:139], v162, s[8:11], 0 offen sc1
    buffer_store_dwordx4 v[140:143], v163, s[8:11], 0 offen sc1
L_hl1_s:
    s_cmp_lg_u32 s3, 11
    s_cbranch_scc1 L_po2
    s_lshl_b32 s30, s21, 3
    s_add_u32 s30, s30, s22
    s_cmp_lg_u32 s34, 2
    s_cbranch_scc1 L_po1
    s_mul_i32 s30, s30, 9216
    s_add_u32 s30, s30, 10485760
    v_mov_b64 v[20:21], 0
    v_mov_b64 v[22:23], 0
    buffer_store_dwordx4 v[20:23], v2, s[8:11], s30 offen offset:0 sc1
    buffer_store_dwordx4 v[20:23], v2, s[8:11], s30 offen offset:1024 sc1
    buffer_store_dwordx4 v[20:23], v2, s[8:11], s30 offen offset:2048 sc1
    buffer_store_dwordx4 v[20:23], v2, s[8:11], s30 offen offset:3072 sc1
    s_add_u32 s30, s30, 4096
    buffer_store_dwordx4 v[20:23], v2, s[8:11], s30 offen offset:0 sc1
    buffer_store_dwordx4 v[20:23], v2, s[8:11], s30 offen offset:1024 sc1
    buffer_store_dwordx4 v[20:23], v2, s[8:11], s30 offen offset:2048 sc1
    buffer_store_dwordx4 v[20:23], v2, s[8:11], s30 offen offset:3072 sc1
    s_add_u32 s30, s30, 4096
    buffer_store_dwordx4 v[20:23], v2, s[8:11], s30 offen offset:0 sc1
L_po1:
    s_cmp_lg_u32 s34, 3
    s_cbranch_scc1 L_po2
    s_lshl_b32 s30, s30, 7
    s_add_u32 s30, s30, 14221312
    v_mov_b32 v7, s39
    s_mov_b64 exec, 1
    buffer_store_dword v7, off, s[8:11], s30 sc1
    s_mov_b64 exec, -1
L_po2:
    s_cmp_lt_u32 s34, 4
    s_cbranch_scc1 L_kp
    s_mov_b32 s16, s40
    s_mov_b32 s17, s41
    s_mov_b32 s18, 663552
    s_mov_b32 s19, 0x00020000
    s_mov_b32 s12, s42
    s_mov_b32 s13, s43
    s_mov_b32 s14, 4718592
    s_mov_b32 s15, 0x00020000
    s_cmp_eq_u32 s62, 0
    s_cbranch_scc1 L_h2
    s_setprio 3
    v_and_b32 v6, 31, v1
    v_lshlrev_b32 v6, 7, v6
    s_mov_b32 s29, 14155776
L_s1_poll:
    buffer_load_dword v7, v6, s[8:11], s29 offen sc1
    s_waitcnt vmcnt(0)
    v_cmp_eq_u32 vcc, s39, v7
    s_cmp_eq_u64 vcc, -1
    s_cbranch_scc1 L_s1_poll_ok
    s_sleep 8
    s_branch L_s1_poll
L_s1_poll_ok:
    v_and_b32 v6, 15, v1
    v_lshrrev_b32 v7, 4, v1
    v_lshlrev_b32 v6, 4, v6
    v_mul_u32_u24 v5, 4864, v7
    v_add_u32 v5, v5, v6
    s_lshl_b32 s28, s60, 4
    s_add_u32 s28, s28, 14680304
    s_mul_i32 s29, s58, 321024
    s_add_u32 s29, s29, s28
    s_mul_i32 s30, s58, 963072
    s_add_u32 s30, s30, s28
    s_add_u32 s30, s30, 155648
    buffer_load_dwordx4 v[8:11], v6, s[8:11], s30 offen sc1
    s_add_u32 s30, s29, 0
    buffer_load_dwordx4 v[16:19], v5, s[8:11], s30 offen sc1
    s_add_u32 s30, s29, 19456
    buffer_load_dwordx4 v[20:23], v5, s[8:11], s30 offen sc1
    v_cmp_gt_u32 vcc, 16, v1
    v_and_b32 v12, 1, v1
    v_lshlrev_b32 v12, 15, v12
    v_or_b32 v12, 0x3f00, v12
    v_cndmask_b32 v12, 0, v12, vcc
    v_mov_b32 v13, 0
    v_mov_b32 v14, 0
    v_mov_b32 v15, 0
    v_mov_b64 v[24:25], 0
    v_mov_b64 v[26:27], 0
    v_mov_b64 v[32:33], 0
    v_mov_b64 v[34:35], 0
    s_waitcnt vmcnt(2)
    s_cmp_eq_u32 s58, 0
    s_cbranch_scc1 L_s2_ev
    v_mfma_f32_16x16x32_bf16 v[32:35], v[8:11], v[12:15], 0
    s_branch L_s2_go
L_s2_ev:
    v_mfma_f32_16x16x32_bf16 v[24:27], v[8:11], v[12:15], 0
L_s2_go:
    s_add_u32 s30, s29, 38912
    buffer_load_dwordx4 v[8:11], v5, s[8:11], s30 offen sc1
    s_add_u32 s30, s29, 58368
    buffer_load_dwordx4 v[12:15], v5, s[8:11], s30 offen sc1
    s_waitcnt vmcnt(3)
    v_mfma_f32_16x16x32_bf16 v[24:27], v[16:19], v[40:43], v[24:27]
    s_add_u32 s30, s29, 77824
    buffer_load_dwordx4 v[16:19], v5, s[8:11], s30 offen sc1
    s_add_u32 s30, s29, 97280
    buffer_load_dwordx4 v[40:43], v5, s[8:11], s30 offen sc1
    s_waitcnt vmcnt(4)
    v_mfma_f32_16x16x32_bf16 v[24:27], v[20:23], v[44:47], v[24:27]
    s_add_u32 s30, s29, 116736
    buffer_load_dwordx4 v[20:23], v5, s[8:11], s30 offen sc1
    s_add_u32 s30, s29, 136192
    buffer_load_dwordx4 v[44:47], v5, s[8:11], s30 offen sc1
    s_waitcnt vmcnt(5)
    v_mfma_f32_16x16x32_bf16 v[24:27], v[8:11], v[48:51], v[24:27]
    s_add_u32 s30, s29, 160512
    buffer_load_dwordx4 v[8:11], v5, s[8:11], s30 offen sc1
    s_add_u32 s30, s29, 179968
    buffer_load_dwordx4 v[48:51], v5, s[8:11], s30 offen sc1
    s_waitcnt vmcnt(6)
    v_mfma_f32_16x16x32_bf16 v[24:27], v[12:15], v[52:55], v[24:27]
    s_add_u32 s30, s29, 199424
    buffer_load_dwordx4 v[12:15], v5, s[8:11], s30 offen sc1
    s_add_u32 s30, s29, 218880
    buffer_load_dwordx4 v[52:55], v5, s[8:11], s30 offen sc1
    s_waitcnt vmcnt(7)
    v_mfma_f32_16x16x32_bf16 v[24:27], v[16:19], v[56:59], v[24:27]
    s_add_u32 s30, s29, 238336
    buffer_load_dwordx4 v[16:19], v5, s[8:11], s30 offen sc1
    s_add_u32 s30, s29, 257792
    buffer_load_dwordx4 v[56:59], v5, s[8:11], s30 offen sc1
    s_waitcnt vmcnt(8)
    v_mfma_f32_16x16x32_bf16 v[24:27], v[40:43], v[60:63], v[24:27]
    s_add_u32 s30, s29, 277248
    buffer_load_dwordx4 v[40:43], v5, s[8:11], s30 offen sc1
    s_add_u32 s30, s29, 296704
    buffer_load_dwordx4 v[60:63], v5, s[8:11], s30 offen sc1
    s_waitcnt vmcnt(9)
    v_mfma_f32_16x16x32_bf16 v[24:27], v[20:23], v[64:67], v[24:27]
    s_add_u32 s30, s29, 642048
    buffer_load_dwordx4 v[20:23], v5, s[8:11], s30 offen sc1
    s_add_u32 s30, s29, 661504
    buffer_load_dwordx4 v[64:67], v5, s[8:11], s30 offen sc1
    s_waitcnt vmcnt(10)
    v_mfma_f32_16x16x32_bf16 v[24:27], v[44:47], v[68:71], v[24:27]
    s_add_u32 s30, s29, 680960
    buffer_load_dwordx4 v[44:47], v5, s[8:11], s30 offen sc1
    s_add_u32 s30, s29, 700416
    buffer_load_dwordx4 v[68:71], v5, s[8:11], s30 offen sc1
    s_waitcnt vmcnt(11)
    v_mfma_f32_16x16x32_bf16 v[28:31], v[8:11], v[72:75], 0
    s_add_u32 s30, s29, 719872
    buffer_load_dwordx4 v[8:11], v5, s[8:11], s30 offen sc1
    s_add_u32 s30, s29, 739328
    buffer_load_dwordx4 v[72:75], v5, s[8:11], s30 offen sc1
    s_waitcnt vmcnt(12)
    v_mfma_f32_16x16x32_bf16 v[28:31], v[48:51], v[76:79], v[28:31]
    s_add_u32 s30, s29, 758784
    buffer_load_dwordx4 v[48:51], v5, s[8:11], s30 offen sc1
    s_add_u32 s30, s29, 778240
    buffer_load_dwordx4 v[76:79], v5, s[8:11], s30 offen sc1
    s_waitcnt vmcnt(13)
    v_mfma_f32_16x16x32_bf16 v[28:31], v[12:15], v[80:83], v[28:31]
    s_add_u32 s30, s29, 802560
    buffer_load_dwordx4 v[12:15], v5, s[8:11], s30 offen sc1
    s_add_u32 s30, s29, 822016
    buffer_load_dwordx4 v[80:83], v5, s[8:11], s30 offen sc1
    s_waitcnt vmcnt(14)
    v_mfma_f32_16x16x32_bf16 v[28:31], v[52:55], v[84:87], v[28:31]
    s_add_u32 s30, s29, 841472
    buffer_load_dwordx4 v[52:55], v5, s[8:11], s30 offen sc1
    s_add_u32 s30, s29, 860928
    buffer_load_dwordx4 v[84:87], v5, s[8:11], s30 offen sc1
    s_waitcnt vmcnt(15)
    v_mfma_f32_16x16x32_bf16 v[28:31], v[16:19], v[88:91], v[28:31]
    s_add_u32 s30, s29, 880384
    buffer_load_dwordx4 v[16:19], v5, s[8:11], s30 offen sc1
    s_add_u32 s30, s29, 899840
    buffer_load_dwordx4 v[88:91], v5, s[8:11], s30 offen sc1
    s_waitcnt vmcnt(16)
    v_mfma_f32_16x16x32_bf16 v[28:31], v[56:59], v[92:95], v[28:31]
    s_add_u32 s30, s29, 919296
    buffer_load_dwordx4 v[56:59], v5, s[8:11], s30 offen sc1
    s_add_u32 s30, s29, 938752
    buffer_load_dwordx4 v[92:95], v5, s[8:11], s30 offen sc1
    s_waitcnt vmcnt(17)
    v_mfma_f32_16x16x32_bf16 v[28:31], v[40:43], v[96:99], v[28:31]
    s_waitcnt vmcnt(16)
    v_mfma_f32_16x16x32_bf16 v[28:31], v[60:63], v[100:103], v[28:31]
    s_waitcnt vmcnt(15)
    v_mfma_f32_16x16x32_bf16 v[32:35], v[20:23], v[104:107], v[32:35]
    s_waitcnt vmcnt(14)
    v_mfma_f32_16x16x32_bf16 v[32:35], v[64:67], v[108:111], v[32:35]
    s_waitcnt vmcnt(13)
    v_mfma_f32_16x16x32_bf16 v[32:35], v[44:47], v[112:115], v[32:35]
    s_waitcnt vmcnt(12)
    v_mfma_f32_16x16x32_bf16 v[32:35], v[68:71], v[116:119], v[32:35]
    s_waitcnt vmcnt(11)
    v_mfma_f32_16x16x32_bf16 v[32:35], v[8:11], v[120:123], v[32:35]
    s_waitcnt vmcnt(10)
    v_mfma_f32_16x16x32_bf16 v[32:35], v[72:75], v[124:127], v[32:35]
    s_waitcnt vmcnt(9)
    v_mfma_f32_16x16x32_bf16 v[32:35], v[48:51], v[128:131], v[32:35]
    s_waitcnt vmcnt(8)
    v_mfma_f32_16x16x32_bf16 v[32:35], v[76:79], v[132:135], v[32:35]
    s_waitcnt vmcnt(7)
    v_mfma_f32_16x16x32_bf16 v[36:39], v[12:15], v[136:139], 0
    s_waitcnt vmcnt(6)
    v_mfma_f32_16x16x32_bf16 v[36:39], v[80:83], v[140:143], v[36:39]
    s_waitcnt vmcnt(5)
    v_mfma_f32_16x16x32_bf16 v[36:39], v[52:55], v[144:147], v[36:39]
    s_waitcnt vmcnt(4)
    v_mfma_f32_16x16x32_bf16 v[36:39], v[84:87], v[148:151], v[36:39]
    s_waitcnt vmcnt(3)
    v_mfma_f32_16x16x32_bf16 v[36:39], v[16:19], v[152:155], v[36:39]
    s_waitcnt vmcnt(2)
    v_mfma_f32_16x16x32_bf16 v[36:39], v[88:91], v[156:159], v[36:39]
    s_waitcnt vmcnt(1)
    v_mfma_f32_16x16x32_bf16 v[36:39], v[56:59], v[160:163], v[36:39]
    s_waitcnt vmcnt(0)
    v_mfma_f32_16x16x32_bf16 v[36:39], v[92:95], v[164:167], v[36:39]
    v_and_b32 v6, 15, v1
    s_lshl_b32 s30, s59, 5
    s_add_u32 s30, s30, s58
    v_lshl_add_u32 v6, v6, 1, s30
    v_mul_u32_u24 v8, 2304, v6
    v_lshlrev_b32 v9, 3, v7
    s_lshl_b32 s28, s60, 1
    v_add_u32 v10, s28, v9
    s_sub_u32 s28, 1146, s28
    s_add_u32 s28, s28, s61
    v_sub_u32 v11, s28, v9
    v_sub_u32 v9, 2359296, v8
    v_add_u32 v16, v8, v10
    v_add_u32 v17, v8, v11
    v_add_u32 v18, v9, v10
    v_add_u32 v19, v9, v11
    s_mov_b32 s29, 2359296
    v_add_u32 v22, 2359296, v18
    v_add_u32 v23, 2359296, v19
    v_cmp_gt_u32 vcc, 513, v6
    v_pk_add_f32 v[40:41], v[24:25], v[28:29]
    v_pk_add_f32 v[44:45], v[24:25], v[28:29] neg_lo:[0,1] neg_hi:[0,1]
    v_pk_add_f32 v[48:49], v[32:33], v[36:37]
    v_pk_add_f32 v[52:53], v[32:33], v[36:37] neg_lo:[0,1] neg_hi:[0,1]
    v_pk_add_f32 v[42:43], v[26:27], v[30:31]
    v_pk_add_f32 v[46:47], v[26:27], v[30:31] neg_lo:[0,1] neg_hi:[0,1]
    v_pk_add_f32 v[50:51], v[34:35], v[38:39]
    v_pk_add_f32 v[54:55], v[34:35], v[38:39] neg_lo:[0,1] neg_hi:[0,1]
    s_mov_b64 exec, vcc
    v_pk_add_f32 v[56:57], v[40:41], v[48:49] neg_lo:[0,1] neg_hi:[0,1]
    v_pk_add_f32 v[58:59], v[42:43], v[50:51] neg_lo:[0,1] neg_hi:[0,1]
    v_cvt_pk_bf16_f32 v72, v56, v57
    v_cvt_pk_bf16_f32 v73, v58, v59
    v_cvt_pk_bf16_f32 v74, v59, v58
    v_cvt_pk_bf16_f32 v75, v57, v56
    buffer_store_dwordx2 v[72:73], v16, s[12:15], 0 offen sc1
    buffer_store_dwordx2 v[74:75], v23, s[12:15], 0 offen sc1
    v_pk_add_f32 v[60:61], v[40:41], v[48:49]
    v_pk_add_f32 v[62:63], v[42:43], v[50:51]
    v_cvt_pk_bf16_f32 v76, v60, v61
    v_cvt_pk_bf16_f32 v77, v62, v63
    v_cvt_pk_bf16_f32 v78, v63, v62
    v_cvt_pk_bf16_f32 v79, v61, v60
    buffer_store_dwordx2 v[76:77], v22, s[12:15], 0 offen sc1
    buffer_store_dwordx2 v[78:79], v17, s[12:15], 0 offen sc1
    v_pk_add_f32 v[64:65], v[44:45], v[52:53]
    v_pk_add_f32 v[66:67], v[46:47], v[54:55]
    v_cvt_pk_bf16_f32 v80, v64, v65
    v_cvt_pk_bf16_f32 v81, v66, v67
    v_cvt_pk_bf16_f32 v82, v67, v66
    v_cvt_pk_bf16_f32 v83, v65, v64
    buffer_store_dwordx2 v[80:81], v18, s[12:15], 0 offen sc1
    buffer_store_dwordx2 v[82:83], v17, s[12:15], s29 offen sc1
    v_pk_add_f32 v[68:69], v[44:45], v[52:53] neg_lo:[0,1] neg_hi:[0,1]
    v_pk_add_f32 v[70:71], v[46:47], v[54:55] neg_lo:[0,1] neg_hi:[0,1]
    v_cvt_pk_bf16_f32 v84, v68, v69
    v_cvt_pk_bf16_f32 v85, v70, v71
    v_cvt_pk_bf16_f32 v86, v71, v70
    v_cvt_pk_bf16_f32 v87, v69, v68
    buffer_store_dwordx2 v[84:85], v16, s[12:15], s29 offen sc1
    buffer_store_dwordx2 v[86:87], v19, s[12:15], 0 offen sc1
    s_mov_b64 exec, -1
    s_setprio 2
L_h2:
    s_lshl_b32 s27, s22, 5
    v_add_u32 v6, s27, v1
    s_lshl_b32 s27, s21, 3
    v_and_b32 v7, 7, v1
    v_add_u32 v7, s27, v7
    v_cmp_gt_u32 vcc, 32, v1
    s_mov_b32 s29, 14221312
    s_nop 0
    v_cndmask_b32 v6, v7, v6, vcc
    v_lshlrev_b32 v6, 7, v6
L_po_poll:
    buffer_load_dword v7, v6, s[8:11], s29 offen sc1
    s_waitcnt vmcnt(0)
    v_cmp_eq_u32 vcc, s39, v7
    s_cmp_eq_u64 vcc, -1
    s_cbranch_scc1 L_po_poll_ok
    s_sleep 8
    s_branch L_po_poll
L_po_poll_ok:
    ds_add_u32 v3, v4 offset:136
    s_cmp_lg_u32 s2, 1
    s_cbranch_scc1 L_rz
    s_cmp_lg_u32 s3, 11
    s_cbranch_scc1 L_rz
    v_lshlrev_b32 v6, 7, v1
    v_add_u32 v8, 8192, v6
    v_add_u32 v9, 16384, v6
    v_add_u32 v10, 24576, v6
L_rz0:
    buffer_load_dword v7, v6, s[8:11], s29 offen sc1
    buffer_load_dword v11, v8, s[8:11], s29 offen sc1
    buffer_load_dword v12, v9, s[8:11], s29 offen sc1
    buffer_load_dword v13, v10, s[8:11], s29 offen sc1
    s_waitcnt vmcnt(0)
    v_xor_b32 v7, s39, v7
    v_xor_b32 v11, s39, v11
    v_xor_b32 v12, s39, v12
    v_xor_b32 v13, s39, v13
    v_or3_b32 v7, v7, v11, v12
    v_or_b32 v7, v7, v13
    v_cmp_ne_u32 vcc, 0, v7
    s_cbranch_vccz L_rz1
    s_sleep 16
    s_branch L_rz0
L_rz1:
    s_mov_b64 exec, 1
    buffer_store_dword v7, off, s[44:47], 0 sc1
    s_mov_b64 exec, -1
L_rz:
    s_lshr_b32 s53, s23, 3
    s_lshr_b32 s27, s23, 2
    s_and_b32 s30, s23, 1
    s_cmp_ge_u32 s23, 8
    s_cselect_b32 s27, s30, s27
    s_sub_u32 s30, s23, 8
    s_cmp_ge_u32 s23, 10
    s_cselect_b32 s53, s30, s53
    s_and_b32 s33, s23, 3
    v_lshlrev_b32 v100, 4, v1
    v_mov_b32 v101, 196608
    s_mov_b32 s28, 159744
    v_writelane_b32 v101, s28, 0
    s_lshl_b32 s5, s27, 2
    v_lshlrev_b32 v104, 2, v1
    v_add_u32 v104, 160000, v104
    v_lshrrev_b32 v32, 4, v1
    s_lshr_b32 s24, s21, 2
    s_lshl_b32 s24, s24, 3
    s_and_b32 s30, s21, 3
    s_add_u32 s24, s24, s30
    s_lshl_b32 s24, s24, 1
    s_add_u32 s24, s24, s27
    s_and_b32 s30, s53, 1
    s_xor_b32 s30, s30, 0
    s_lshl_b32 s30, s30, 3
    s_add_u32 s24, s24, s30
    s_mul_i32 s24, s24, 36864
    s_mul_i32 s25, s22, 144
    s_add_u32 s24, s24, s25
    s_add_u32 s48, s24, 1152
    s_mul_i32 s28, s27, 13824
    s_add_u32 s28, s28, 100352
    s_mul_i32 s32, s27, 4608
    s_add_u32 s32, s32, 143360
    s_mul_i32 s51, s27, 78848
    s_add_u32 s51, s51, 49152
    s_cmp_eq_u32 s53, 0
    s_cselect_b32 s51, s51, s28
    s_cselect_b32 s33, s33, 3
    s_mul_i32 s30, s33, 4608
    s_add_u32 s28, s28, s30
    s_mul_i32 s34, s33, 5
    s_cmp_eq_u32 s33, 3
    s_cselect_b32 s6, s32, s28
    s_cselect_b32 s34, 14, s34
    s_cmp_lt_u32 s33, 2
    s_cselect_b32 s52, 0, 0x0101
    s_cselect_b32 s35, 0, 24576
    s_and_b32 s30, s52, 1
    s_sub_u32 s34, s34, s30
    s_mov_b32 s20, s34
    s_lshl_b32 s26, s21, 2
    s_add_u32 s26, s26, s27
    s_mul_i32 s26, s26, 18
    s_add_u32 s26, s26, s34
    s_lshl_b32 s26, s26, 10
    s_add_u32 s49, s26, 10485760
    s_add_u32 s50, s49, 36864
    s_lshl_b32 s30, s34, 12
    s_add_u32 s35, s35, s30
    v_bfe_u32 v33, v1, 2, 2
    v_lshl_add_u32 v34, v32, 3, v33
    v_and_b32 v35, 3, v1
    v_lshrrev_b32 v33, 1, v33
    v_and_b32 v32, 1, v32
    v_lshl_or_b32 v33, v32, 1, v33
    v_lshlrev_b32 v36, 7, v34
    v_lshl_add_u32 v36, v35, 3, v36
    v_add_u32 v36, s35, v36
    v_xor_b32 v32, 0, v33
    v_lshl_add_u32 v110, v32, 5, v36
    v_xor_b32 v32, 1, v33
    v_lshl_add_u32 v114, v32, 5, v36
    v_xor_b32 v32, 2, v33
    v_lshl_add_u32 v118, v32, 5, v36
    v_xor_b32 v32, 3, v33
    v_lshl_add_u32 v122, v32, 5, v36
    v_and_b32 v35, 1, v35
    v_lshlrev_b32 v35, 3, v35
    v_lshl_add_u32 v35, v34, 4, v35
    s_lshl_b32 s28, s34, 9
    s_add_u32 s28, s28, 40960
    s_cmp_eq_u32 s33, 3
    s_cselect_b32 s28, 97792, s28
    v_add_u32 v126, s28, v35
    s_lshl_b32 s4, s21, 14
    s_add_u32 s4, s4, 13107200
    v_lshlrev_b32 v64, 8, v1
    v_and_b32 v65, 32, v1
    v_lshlrev_b32 v65, 2, v65
    v_add_u32 v65, 160000, v65
    v_bfe_u32 v66, v1, 1, 4
    v_lshl_add_u32 v68, v66, 2, v65
    v_bfe_u32 v66, v1, 4, 1
    v_lshl_add_u32 v69, v66, 2, v65
    v_add_u32 v69, 64, v69
    v_mov_b32 v65, 4194304
    s_cmp_eq_u32 s23, 3
    s_cselect_b64 s[58:59], -1, 0
    s_cbranch_scc0 L_p3_rd0
    ds_write_b32 v104, v65
L_p3_rd0:
    v_and_b32 v2, 63, v0
    s_mul_i32 s24, s22, 144
    s_and_b32 s25, s23, 1
    s_lshl_b32 s25, s25, 2
    v_bfe_u32 v6, v2, 4, 1
    v_lshlrev_b32 v6, 1, v6
    v_or_b32 v6, s25, v6
    v_and_b32 v7, 7, v2
    v_xor_b32 v6, v6, v7
    v_lshlrev_b32 v6, 4, v6
    v_lshrrev_b32 v7, 3, v2
    v_mul_u32_u24 v8, 1152, v7
    v_add_u32 v8, v8, v6
    v_lshrrev_b32 v9, 1, v7
    v_mul_u32_u24 v9, 18, v9
    v_and_b32 v7, 1, v7
    v_add_u32 v9, v9, v7
    v_mul_u32_u24 v9, 1152, v9
    v_add_u32 v9, v9, v6
    v_lshrrev_b32 v10, 4, v2
    v_mul_u32_u24 v10, 18, v10
    v_and_b32 v7, 15, v2
    v_add_u32 v10, v10, v7
    v_mul_u32_u24 v10, 1152, v10
    v_lshrrev_b32 v11, 1, v2
    v_mul_u32_u24 v11, 18, v11
    v_and_b32 v7, 1, v2
    v_add_u32 v11, v11, v7
    v_mul_u32_u24 v11, 1152, v11
    s_lshr_b32 s26, s23, 1
    s_mul_i32 s26, s26, 18
    s_lshl_b32 s27, s25, 1
    s_add_u32 s26, s26, s27
    s_mul_i32 s26, s26, 1152
    s_add_u32 s26, s26, s24
    s_mul_i32 s31, s23, 82944
    s_add_u32 s31, s31, s24
    s_lshl_b32 s27, s23, 10
    s_add_u32 s32, s31, 128
L_p3_w0a:
    ds_read_b32 v5, v3 offset:120
    s_waitcnt lgkmcnt(0)
    v_readfirstlane_b32 s30, v5
    s_cmp_ge_u32 s30, 8
    s_cbranch_scc1 L_p3_w0a_ok
    s_sleep 16
    s_branch L_p3_w0a
L_p3_w0a_ok:
    s_add_u32 m0, s27, 0
    s_add_u32 s28, s26, 0
    buffer_load_dwordx4 v8, s[16:19], s28 offen lds
    s_add_u32 m0, s27, 4096
    s_add_u32 s28, s26, 41472
    buffer_load_dwordx4 v8, s[16:19], s28 offen lds
    s_add_u32 m0, s27, 8192
    s_add_u32 s28, s26, 82944
    buffer_load_dwordx4 v8, s[16:19], s28 offen lds
    s_add_u32 m0, s27, 12288
    s_add_u32 s28, s26, 124416
    buffer_load_dwordx4 v8, s[16:19], s28 offen lds
    s_add_u32 m0, s27, 16384
    s_add_u32 s28, s26, 165888
    buffer_load_dwordx4 v8, s[16:19], s28 offen lds
    s_add_u32 m0, s27, 20480
    s_add_u32 s28, s26, 207360
    buffer_load_dwordx4 v8, s[16:19], s28 offen lds
    s_add_u32 m0, s27, 24576
    s_add_u32 s28, s26, 248832
    buffer_load_dwordx4 v8, s[16:19], s28 offen lds
    s_add_u32 m0, s27, 28672
    s_add_u32 s28, s26, 290304
    buffer_load_dwordx4 v8, s[16:19], s28 offen lds
    s_add_u32 m0, s27, 65536
    s_add_u32 s28, s26, 414720
    buffer_load_dwordx4 v8, s[16:19], s28 offen lds
    s_add_u32 m0, s27, 69632
    s_add_u32 s28, s26, 456192
    buffer_load_dwordx4 v8, s[16:19], s28 offen lds
    s_add_u32 m0, s27, 73728
    s_add_u32 s28, s26, 497664
    buffer_load_dwordx4 v8, s[16:19], s28 offen lds
    s_add_u32 m0, s27, 77824
    s_add_u32 s28, s26, 539136
    buffer_load_dwordx4 v8, s[16:19], s28 offen lds
    s_add_u32 m0, s27, 81920
    s_add_u32 s28, s26, 580608
    buffer_load_dwordx4 v8, s[16:19], s28 offen lds
    s_add_u32 m0, s27, 86016
    s_add_u32 s28, s26, 622080
    buffer_load_dwordx4 v8, s[16:19], s28 offen lds
    s_add_u32 m0, s27, 90112
    s_add_u32 s28, s31, 18432
    buffer_load_dwordx4 v9, s[16:19], s28 offen lds
    s_add_u32 m0, s27, 94208
    s_add_u32 s28, s31, 350208
    buffer_load_dwordx4 v9, s[16:19], s28 offen lds
L_p3_w0:
    ds_read_b32 v5, v3 offset:124
    s_waitcnt lgkmcnt(0)
    v_readfirstlane_b32 s30, v5
    s_cmp_ge_u32 s30, 8
    s_cbranch_scc1 L_p3_w0_ok
    s_sleep 8
    s_branch L_p3_w0
L_p3_w0_ok:
    s_add_u32 m0, s27, 32768
    s_add_u32 s28, s26, 331776
    buffer_load_dwordx4 v8, s[16:19], s28 offen lds
    s_add_u32 m0, s27, 36864
    s_add_u32 s28, s26, 373248
    buffer_load_dwordx4 v8, s[16:19], s28 offen lds
    s_add_u32 m0, s27, 40960
    s_add_u32 s29, s27, 45056
    buffer_load_dwordx4 v10, s[16:19], s32 offen lds
    s_cmp_eq_u32 s23, 3
    s_cselect_b32 m0, 98304, s29
    s_add_u32 s32, s32, 331776
    buffer_load_dwordx4 v10, s[16:19], s32 offen lds
    s_cmp_lg_u32 s23, 0
    s_cbranch_scc1 L_p3_wo1
    s_mov_b32 m0, 99328
    s_add_u32 s32, s24, 18560
    buffer_load_dwordx4 v11, s[16:19], s32 offen lds
L_p3_wo1:
    s_waitcnt vmcnt(0)
    ds_add_u32 v3, v4 offset:128
    s_setprio 1
    s_branch L_tail
L_fn:
    s_mov_b32 s12, s48
    s_mov_b32 s13, s49
    s_mov_b32 s14, 2359296
    s_mov_b32 s15, 0x00020000
    s_sub_u32 s24, s26, 28
    s_lshl_b32 s24, s24, 3
    s_and_b32 s27, s2, 7
    s_add_u32 s24, s24, s27
    v_min_u32 v2, 679, v0
    s_lshl_b32 s26, s24, 4
    v_mul_u32_u24 v3, 1639, v2
    v_lshrrev_b32 v3, 16, v3
    v_mul_u32_u24 v4, 40, v3
    v_sub_u32 v4, v2, v4
    v_add_u32 v5, s26, v3
    v_cmp_eq_u32 s[30:31], 16, v3
    v_mov_b32 v6, 512
    v_cmp_gt_u32 vcc, 36, v4
    v_cndmask_b32 v5, v5, v6, s[30:31]
    v_lshlrev_b32 v6, 4, v4
    v_add_u32 v7, 2, v6
    v_sub_u32 v6, 1136, v6
    v_mov_b32 v8, 1073741824
    v_cndmask_b32 v7, 0, v7, vcc
    v_cndmask_b32 v6, v8, v6, vcc
    v_mul_u32_u24 v8, 1152, v5
    v_sub_u32 v9, 2048, v5
    v_and_b32 v9, 2047, v9
    v_mul_u32_u24 v9, 1152, v9
    v_add_u32 v10, v8, v7
    v_add_u32 v11, v8, v6
    v_add_u32 v12, v9, v7
    v_add_u32 v13, v9, v6
    s_mov_b32 s27, 1179648
    buffer_load_dwordx4 v[16:19], v10, s[12:15], 0 offen
    buffer_load_dwordx4 v[20:23], v11, s[12:15], 0 offen
    buffer_load_dwordx4 v[24:27], v12, s[12:15], 0 offen
    buffer_load_dwordx4 v[28:31], v13, s[12:15], 0 offen
    v_sub_u32 v8, s27, v8
    v_add_u32 v12, v8, v7
    v_add_u32 v13, v8, v6
    buffer_load_dwordx4 v[32:35], v10, s[12:15], s27 offen
    buffer_load_dwordx4 v[36:39], v11, s[12:15], s27 offen
    buffer_load_dwordx4 v[40:43], v12, s[12:15], 0 offen
    buffer_load_dwordx4 v[44:47], v13, s[12:15], 0 offen
    v_and_b32 v6, 1, v3
    v_lshlrev_b32 v6, 2, v6
    v_bfe_u32 v7, v3, 1, 2
    v_add_u32 v6, v6, v7
    v_and_b32 v7, 8, v3
    v_add_u32 v6, v6, v7
    v_add_u32 v7, 16, v6
    v_cndmask_b32 v6, v6, 32, s[30:31]
    v_cndmask_b32 v7, v7, 33, s[30:31]
    v_mul_u32_u24 v6, 336, v6
    v_mul_u32_u24 v7, 336, v7
    v_lshl_add_u32 v10, v4, 3, v6
    v_lshl_add_u32 v11, v4, 3, v7
    s_and_b32 s28, s3, 1
    s_lshr_b32 s29, s3, 1
    s_mov_b32 s32, s24
    s_cmp_lt_u32 s3, 10
    s_cselect_b32 s29, s29, s24
    s_cselect_b32 s32, s32, 32
    v_mov_b32 v14, 1073741824
    v_mov_b32 v15, 1073741824
    s_mov_b32 s34, 0
    s_mov_b32 s35, 0
    s_cmp_ge_u32 s29, 5
    s_cbranch_scc1 L_s1_fold
    s_lshl_b32 s30, s29, 5
    v_and_b32 v2, 31, v1
    v_lshrrev_b32 v3, 5, v1
    v_add_u32 v4, s30, v2
    v_cvt_f32_u32 v128, v4
    v_mul_f32 v128, 0x3ae38e39, v128
    v_lshlrev_b32 v5, 4, v3
    v_add_u32 v5, 2, v5
    v_subrev_u32 v5, s28, v5
    v_cvt_f32_u32 v5, v5
    s_cmp_eq_u32 s28, 0
    s_cselect_b32 s30, 0, 0xbe800000
    s_cselect_b32 s31, -1.0, 1.0
    s_cselect_b32 s33, 0.5, 1.0
    v_mul_f32 v130, 32.0, v128
    v_fma_f32 v129, v128, v5, s30
    v_cos_f32 v130, v130
    v_fma_f32 v133, v128, s31, v129
    v_mov_b32 v132, 1.0
    v_add_f32 v130, v130, v130
    s_mov_b32 exec_lo, 0
    v_mov_b32 v132, s33
    s_mov_b32 exec_lo, -1
    v_mov_b32 v96, v129
    v_fmamk_f32 v97, v128, 0x40000000, v129
    v_fmamk_f32 v98, v128, 0x40800000, v129
    v_fmamk_f32 v99, v128, 0x40c00000, v129
    v_fmamk_f32 v100, v128, 0x41000000, v129
    v_fmamk_f32 v101, v128, 0x41200000, v129
    v_fmamk_f32 v102, v128, 0x41400000, v129
    v_fmamk_f32 v103, v128, 0x41600000, v129
    v_cos_f32 v96, v96
    v_cos_f32 v97, v97
    v_cos_f32 v98, v98
    v_cos_f32 v99, v99
    v_cos_f32 v100, v100
    v_cos_f32 v101, v101
    v_cos_f32 v102, v102
    v_cos_f32 v103, v103
    v_fmamk_f32 v104, v128, 0x42000000, v129
    v_fmamk_f32 v105, v128, 0x42080000, v129
    v_fmamk_f32 v106, v128, 0x42100000, v129
    v_fmamk_f32 v107, v128, 0x42180000, v129
    v_fmamk_f32 v108, v128, 0x42200000, v129
    v_fmamk_f32 v109, v128, 0x42280000, v129
    v_fmamk_f32 v110, v128, 0x42300000, v129
    v_fmamk_f32 v111, v128, 0x42380000, v129
    v_cos_f32 v104, v104
    v_cos_f32 v105, v105
    v_cos_f32 v106, v106
    v_cos_f32 v107, v107
    v_cos_f32 v108, v108
    v_cos_f32 v109, v109
    v_cos_f32 v110, v110
    v_cos_f32 v111, v111
    v_cvt_pk_bf16_f32 v136, v96, v97
    v_cvt_pk_bf16_f32 v137, v98, v99
    v_cvt_pk_bf16_f32 v138, v100, v101
    v_cvt_pk_bf16_f32 v139, v102, v103
    v_mov_b32 v112, v133
    v_fmamk_f32 v113, v128, 0x40000000, v133
    v_fmamk_f32 v114, v128, 0x40800000, v133
    v_fmamk_f32 v115, v128, 0x40c00000, v133
    v_fmamk_f32 v116, v128, 0x41000000, v133
    v_fmamk_f32 v117, v128, 0x41200000, v133
    v_fmamk_f32 v118, v128, 0x41400000, v133
    v_fmamk_f32 v119, v128, 0x41600000, v133
    v_cos_f32 v112, v112
    v_cos_f32 v113, v113
    v_cos_f32 v114, v114
    v_cos_f32 v115, v115
    v_cos_f32 v116, v116
    v_cos_f32 v117, v117
    v_cos_f32 v118, v118
    v_cos_f32 v119, v119
    v_fmamk_f32 v120, v128, 0x42000000, v133
    v_fmamk_f32 v121, v128, 0x42080000, v133
    v_fmamk_f32 v122, v128, 0x42100000, v133
    v_fmamk_f32 v123, v128, 0x42180000, v133
    v_fmamk_f32 v124, v128, 0x42200000, v133
    v_fmamk_f32 v125, v128, 0x42280000, v133
    v_fmamk_f32 v126, v128, 0x42300000, v133
    v_fmamk_f32 v127, v128, 0x42380000, v133
    v_cos_f32 v120, v120
    v_cos_f32 v121, v121
    v_cos_f32 v122, v122
    v_cos_f32 v123, v123
    v_cos_f32 v124, v124
    v_cos_f32 v125, v125
    v_cos_f32 v126, v126
    v_cos_f32 v127, v127
    v_cvt_pk_bf16_f32 v140, v112, v113
    v_cvt_pk_bf16_f32 v141, v114, v115
    v_cvt_pk_bf16_f32 v142, v116, v117
    v_cvt_pk_bf16_f32 v143, v118, v119
    s_add_u32 s30, s28, 32
    v_mov_b32 v5, s30
    s_cmp_lt_u32 s3, 10
    s_cselect_b64 vcc, -1, 0
    s_mul_i32 s31, s28, 11424
    v_cndmask_b32 v5, v5, v2, vcc
    v_mul_u32_u24 v5, 336, v5
    v_lshl_add_u32 v5, v3, 4, v5
    s_add_u32 s30, s31, 11424
    s_mul_i32 s31, s31, 3
    v_add_u32 v12, s30, v5
    v_add_u32 v13, s31, v5
    v_mul_u32_u24 v5, 160512, v3
    v_mov_b32 v6, 1073741824
    v_cmp_gt_u32 vcc, 145, v4
    v_lshl_add_u32 v14, v4, 4, v5
    v_add_u32 v14, 240, v14
    v_cndmask_b32 v14, v6, v14, vcc
    v_cmp_gt_u32 vcc, 144, v4
    v_lshlrev_b32 v7, 4, v4
    v_sub_u32 v15, v5, v7
    v_add_u32 v15, 4848, v15
    v_cndmask_b32 v15, v6, v15, vcc
    s_mul_i32 s34, s28, 642048
    s_mul_i32 s30, s32, 4864
    s_add_u32 s34, s34, s30
    s_add_u32 s34, s34, 14680064
    s_add_u32 s35, s34, 321024
L_s1_fold:
    s_mov_b32 s30, 0xffff0000
    s_waitcnt vmcnt(6)
    v_lshlrev_b32 v48, 16, v16
    v_and_b32 v52, s30, v16
    v_and_b32 v56, s30, v23
    v_lshlrev_b32 v60, 16, v23
    v_lshlrev_b32 v49, 16, v17
    v_and_b32 v53, s30, v17
    v_and_b32 v57, s30, v22
    v_lshlrev_b32 v61, 16, v22
    v_lshlrev_b32 v50, 16, v18
    v_and_b32 v54, s30, v18
    v_and_b32 v58, s30, v21
    v_lshlrev_b32 v62, 16, v21
    v_lshlrev_b32 v51, 16, v19
    v_and_b32 v55, s30, v19
    v_and_b32 v59, s30, v20
    v_lshlrev_b32 v63, 16, v20
    v_pk_add_f32 v[64:65], v[48:49], v[56:57]
    v_pk_add_f32 v[72:73], v[48:49], v[56:57] neg_lo:[0,1] neg_hi:[0,1]
    v_pk_add_f32 v[66:67], v[50:51], v[58:59]
    v_pk_add_f32 v[74:75], v[50:51], v[58:59] neg_lo:[0,1] neg_hi:[0,1]
    v_pk_add_f32 v[68:69], v[52:53], v[60:61]
    v_pk_add_f32 v[76:77], v[52:53], v[60:61] neg_lo:[0,1] neg_hi:[0,1]
    v_pk_add_f32 v[70:71], v[54:55], v[62:63]
    v_pk_add_f32 v[78:79], v[54:55], v[62:63] neg_lo:[0,1] neg_hi:[0,1]
    s_waitcnt vmcnt(4)
    v_lshlrev_b32 v48, 16, v24
    v_and_b32 v52, s30, v24
    v_and_b32 v56, s30, v31
    v_lshlrev_b32 v60, 16, v31
    v_lshlrev_b32 v49, 16, v25
    v_and_b32 v53, s30, v25
    v_and_b32 v57, s30, v30
    v_lshlrev_b32 v61, 16, v30
    v_lshlrev_b32 v50, 16, v26
    v_and_b32 v54, s30, v26
    v_and_b32 v58, s30, v29
    v_lshlrev_b32 v62, 16, v29
    v_lshlrev_b32 v51, 16, v27
    v_and_b32 v55, s30, v27
    v_and_b32 v59, s30, v28
    v_lshlrev_b32 v63, 16, v28
    v_pk_add_f32 v[64:65], v[64:65], v[48:49]
    v_pk_add_f32 v[72:73], v[72:73], v[48:49] neg_lo:[0,1] neg_hi:[0,1]
    v_pk_add_f32 v[66:67], v[66:67], v[50:51]
    v_pk_add_f32 v[74:75], v[74:75], v[50:51] neg_lo:[0,1] neg_hi:[0,1]
    v_pk_add_f32 v[68:69], v[68:69], v[52:53]
    v_pk_add_f32 v[76:77], v[76:77], v[52:53] neg_lo:[0,1] neg_hi:[0,1]
    v_pk_add_f32 v[70:71], v[70:71], v[54:55]
    v_pk_add_f32 v[78:79], v[78:79], v[54:55] neg_lo:[0,1] neg_hi:[0,1]
    v_pk_add_f32 v[64:65], v[64:65], v[56:57]
    v_pk_add_f32 v[72:73], v[72:73], v[56:57]
    v_pk_add_f32 v[66:67], v[66:67], v[58:59]
    v_pk_add_f32 v[74:75], v[74:75], v[58:59]
    v_pk_add_f32 v[68:69], v[68:69], v[60:61]
    v_pk_add_f32 v[76:77], v[76:77], v[60:61]
    v_pk_add_f32 v[70:71], v[70:71], v[62:63]
    v_pk_add_f32 v[78:79], v[78:79], v[62:63]
    s_waitcnt vmcnt(2)
    v_lshlrev_b32 v48, 16, v32
    v_and_b32 v52, s30, v32
    v_and_b32 v56, s30, v39
    v_lshlrev_b32 v60, 16, v39
    v_lshlrev_b32 v49, 16, v33
    v_and_b32 v53, s30, v33
    v_and_b32 v57, s30, v38
    v_lshlrev_b32 v61, 16, v38
    v_lshlrev_b32 v50, 16, v34
    v_and_b32 v54, s30, v34
    v_and_b32 v58, s30, v37
    v_lshlrev_b32 v62, 16, v37
    v_lshlrev_b32 v51, 16, v35
    v_and_b32 v55, s30, v35
    v_and_b32 v59, s30, v36
    v_lshlrev_b32 v63, 16, v36
    v_pk_add_f32 v[80:81], v[48:49], v[56:57]
    v_pk_add_f32 v[88:89], v[48:49], v[56:57] neg_lo:[0,1] neg_hi:[0,1]
    v_pk_add_f32 v[82:83], v[50:51], v[58:59]
    v_pk_add_f32 v[90:91], v[50:51], v[58:59] neg_lo:[0,1] neg_hi:[0,1]
    v_pk_add_f32 v[84:85], v[52:53], v[60:61]
    v_pk_add_f32 v[92:93], v[52:53], v[60:61] neg_lo:[0,1] neg_hi:[0,1]
    v_pk_add_f32 v[86:87], v[54:55], v[62:63]
    v_pk_add_f32 v[94:95], v[54:55], v[62:63] neg_lo:[0,1] neg_hi:[0,1]
    s_waitcnt vmcnt(0)
    v_lshlrev_b32 v48, 16, v40
    v_and_b32 v52, s30, v40
    v_and_b32 v56, s30, v47
    v_lshlrev_b32 v60, 16, v47
    v_lshlrev_b32 v49, 16, v41
    v_and_b32 v53, s30, v41
    v_and_b32 v57, s30, v46
    v_lshlrev_b32 v61, 16, v46
    v_lshlrev_b32 v50, 16, v42
    v_and_b32 v54, s30, v42
    v_and_b32 v58, s30, v45
    v_lshlrev_b32 v62, 16, v45
    v_lshlrev_b32 v51, 16, v43
    v_and_b32 v55, s30, v43
    v_and_b32 v59, s30, v44
    v_lshlrev_b32 v63, 16, v44
    v_pk_add_f32 v[80:81], v[80:81], v[48:49]
    v_pk_add_f32 v[88:89], v[88:89], v[48:49] neg_lo:[0,1] neg_hi:[0,1]
    v_pk_add_f32 v[82:83], v[82:83], v[50:51]
    v_pk_add_f32 v[90:91], v[90:91], v[50:51] neg_lo:[0,1] neg_hi:[0,1]
    v_pk_add_f32 v[84:85], v[84:85], v[52:53]
    v_pk_add_f32 v[92:93], v[92:93], v[52:53] neg_lo:[0,1] neg_hi:[0,1]
    v_pk_add_f32 v[86:87], v[86:87], v[54:55]
    v_pk_add_f32 v[94:95], v[94:95], v[54:55] neg_lo:[0,1] neg_hi:[0,1]
    v_pk_add_f32 v[80:81], v[80:81], v[56:57]
    v_pk_add_f32 v[88:89], v[88:89], v[56:57]
    v_pk_add_f32 v[82:83], v[82:83], v[58:59]
    v_pk_add_f32 v[90:91], v[90:91], v[58:59]
    v_pk_add_f32 v[84:85], v[84:85], v[60:61]
    v_pk_add_f32 v[92:93], v[92:93], v[60:61]
    v_pk_add_f32 v[86:87], v[86:87], v[62:63]
    v_pk_add_f32 v[94:95], v[94:95], v[62:63]
    v_pk_add_f32 v[48:49], v[64:65], v[80:81]
    v_pk_add_f32 v[50:51], v[66:67], v[82:83]
    v_pk_add_f32 v[52:53], v[68:69], v[84:85]
    v_pk_add_f32 v[54:55], v[70:71], v[86:87]
    v_cvt_pk_bf16_f32 v16, v48, v49
    v_cvt_pk_bf16_f32 v17, v50, v51
    v_cvt_pk_bf16_f32 v18, v52, v53
    v_cvt_pk_bf16_f32 v19, v54, v55
    ds_write_b64 v10, v[16:17] offset:0
    ds_write_b64 v10, v[18:19] offset:11424
    v_pk_add_f32 v[56:57], v[64:65], v[80:81] neg_lo:[0,1] neg_hi:[0,1]
    v_pk_add_f32 v[58:59], v[66:67], v[82:83] neg_lo:[0,1] neg_hi:[0,1]
    v_pk_add_f32 v[60:61], v[68:69], v[84:85] neg_lo:[0,1] neg_hi:[0,1]
    v_pk_add_f32 v[62:63], v[70:71], v[86:87] neg_lo:[0,1] neg_hi:[0,1]
    v_cvt_pk_bf16_f32 v20, v56, v57
    v_cvt_pk_bf16_f32 v21, v58, v59
    v_cvt_pk_bf16_f32 v22, v60, v61
    v_cvt_pk_bf16_f32 v23, v62, v63
    ds_write_b64 v11, v[20:21] offset:0
    ds_write_b64 v11, v[22:23] offset:11424
    v_pk_add_f32 v[48:49], v[72:73], v[88:89]
    v_pk_add_f32 v[50:51], v[74:75], v[90:91]
    v_pk_add_f32 v[52:53], v[76:77], v[92:93]
    v_pk_add_f32 v[54:55], v[78:79], v[94:95]
    v_cvt_pk_bf16_f32 v24, v48, v49
    v_cvt_pk_bf16_f32 v25, v50, v51
    v_cvt_pk_bf16_f32 v26, v52, v53
    v_cvt_pk_bf16_f32 v27, v54, v55
    ds_write_b64 v10, v[24:25] offset:22848
    ds_write_b64 v10, v[26:27] offset:34272
    v_pk_add_f32 v[56:57], v[72:73], v[88:89] neg_lo:[0,1] neg_hi:[0,1]
    v_pk_add_f32 v[58:59], v[74:75], v[90:91] neg_lo:[0,1] neg_hi:[0,1]
    v_pk_add_f32 v[60:61], v[76:77], v[92:93] neg_lo:[0,1] neg_hi:[0,1]
    v_pk_add_f32 v[62:63], v[78:79], v[94:95] neg_lo:[0,1] neg_hi:[0,1]
    v_cvt_pk_bf16_f32 v28, v56, v57
    v_cvt_pk_bf16_f32 v29, v58, v59
    v_cvt_pk_bf16_f32 v30, v60, v61
    v_cvt_pk_bf16_f32 v31, v62, v63
    ds_write_b64 v11, v[28:29] offset:22848
    ds_write_b64 v11, v[30:31] offset:34272
    s_cmp_eq_u32 s28, 0
    s_cselect_b32 s30, 0x3f80, 0
    v_mov_b32 v92, 0
    v_mov_b32 v93, 0
    v_mov_b32 v94, 0
    v_mov_b32 v95, 0
    s_mov_b32 exec_hi, 0
    v_mov_b32 v92, s30
    s_mov_b32 exec_hi, -1
    s_waitcnt lgkmcnt(0)
    s_barrier
    s_cmp_ge_u32 s29, 5
    s_cbranch_scc1 L_s1_skip
    ds_read_b128 v[16:19], v12 offset:0
    ds_read_b128 v[20:23], v13 offset:0
    ds_read_b128 v[24:27], v12 offset:32
    ds_read_b128 v[28:31], v13 offset:32
    ds_read_b128 v[32:35], v12 offset:64
    ds_read_b128 v[36:39], v13 offset:64
    ds_read_b128 v[40:43], v12 offset:96
    ds_read_b128 v[44:47], v13 offset:96
    s_waitcnt lgkmcnt(7)
    v_mfma_f32_32x32x16_bf16 v[48:63], v[16:19], v[136:139], 0
    ds_read_b128 v[16:19], v12 offset:128
    v_cvt_pk_bf16_f32 v144, v104, v105
    v_cvt_pk_bf16_f32 v145, v106, v107
    v_cvt_pk_bf16_f32 v146, v108, v109
    v_cvt_pk_bf16_f32 v147, v110, v111
    s_waitcnt lgkmcnt(7)
    v_mfma_f32_32x32x16_bf16 v[64:79], v[20:23], v[140:143], 0
    ds_read_b128 v[20:23], v13 offset:128
    v_cvt_pk_bf16_f32 v148, v120, v121
    v_cvt_pk_bf16_f32 v149, v122, v123
    v_cvt_pk_bf16_f32 v150, v124, v125
    v_cvt_pk_bf16_f32 v151, v126, v127
    s_waitcnt lgkmcnt(7)
    v_mfma_f32_32x32x16_bf16 v[48:63], v[24:27], v[144:147], v[48:63]
    ds_read_b128 v[24:27], v12 offset:160
    v_pk_fma_f32 v[96:97], v[104:105], v[130:131], v[96:97] op_sel_hi:[1,0,1] neg_lo:[0,0,1] neg_hi:[0,0,1]
    v_pk_fma_f32 v[98:99], v[106:107], v[130:131], v[98:99] op_sel_hi:[1,0,1] neg_lo:[0,0,1] neg_hi:[0,0,1]
    v_pk_fma_f32 v[100:101], v[108:109], v[130:131], v[100:101] op_sel_hi:[1,0,1] neg_lo:[0,0,1] neg_hi:[0,0,1]
    v_pk_fma_f32 v[102:103], v[110:111], v[130:131], v[102:103] op_sel_hi:[1,0,1] neg_lo:[0,0,1] neg_hi:[0,0,1]
    v_cvt_pk_bf16_f32 v136, v96, v97
    v_cvt_pk_bf16_f32 v137, v98, v99
    v_cvt_pk_bf16_f32 v138, v100, v101
    v_cvt_pk_bf16_f32 v139, v102, v103
    s_waitcnt lgkmcnt(7)
    v_mfma_f32_32x32x16_bf16 v[64:79], v[28:31], v[148:151], v[64:79]
    ds_read_b128 v[28:31], v13 offset:160
    v_pk_fma_f32 v[112:113], v[120:121], v[130:131], v[112:113] op_sel_hi:[1,0,1] neg_lo:[0,0,1] neg_hi:[0,0,1]
    v_pk_fma_f32 v[114:115], v[122:123], v[130:131], v[114:115] op_sel_hi:[1,0,1] neg_lo:[0,0,1] neg_hi:[0,0,1]
    v_pk_fma_f32 v[116:117], v[124:125], v[130:131], v[116:117] op_sel_hi:[1,0,1] neg_lo:[0,0,1] neg_hi:[0,0,1]
    v_pk_fma_f32 v[118:119], v[126:127], v[130:131], v[118:119] op_sel_hi:[1,0,1] neg_lo:[0,0,1] neg_hi:[0,0,1]
    v_cvt_pk_bf16_f32 v140, v112, v113
    v_cvt_pk_bf16_f32 v141, v114, v115
    v_cvt_pk_bf16_f32 v142, v116, v117
    v_cvt_pk_bf16_f32 v143, v118, v119
    s_waitcnt lgkmcnt(7)
    v_mfma_f32_32x32x16_bf16 v[48:63], v[32:35], v[136:139], v[48:63]
    ds_read_b128 v[32:35], v12 offset:192
    v_pk_fma_f32 v[104:105], v[96:97], v[130:131], v[104:105] op_sel_hi:[1,0,1] neg_lo:[0,0,1] neg_hi:[0,0,1]
    v_pk_fma_f32 v[106:107], v[98:99], v[130:131], v[106:107] op_sel_hi:[1,0,1] neg_lo:[0,0,1] neg_hi:[0,0,1]
    v_pk_fma_f32 v[108:109], v[100:101], v[130:131], v[108:109] op_sel_hi:[1,0,1] neg_lo:[0,0,1] neg_hi:[0,0,1]
    v_pk_fma_f32 v[110:111], v[102:103], v[130:131], v[110:111] op_sel_hi:[1,0,1] neg_lo:[0,0,1] neg_hi:[0,0,1]
    v_cvt_pk_bf16_f32 v144, v104, v105
    v_cvt_pk_bf16_f32 v145, v106, v107
    v_cvt_pk_bf16_f32 v146, v108, v109
    v_cvt_pk_bf16_f32 v147, v110, v111
    s_waitcnt lgkmcnt(7)
    v_mfma_f32_32x32x16_bf16 v[64:79], v[36:39], v[140:143], v[64:79]
    ds_read_b128 v[36:39], v13 offset:192
    v_pk_fma_f32 v[120:121], v[112:113], v[130:131], v[120:121] op_sel_hi:[1,0,1] neg_lo:[0,0,1] neg_hi:[0,0,1]
    v_pk_fma_f32 v[122:123], v[114:115], v[130:131], v[122:123] op_sel_hi:[1,0,1] neg_lo:[0,0,1] neg_hi:[0,0,1]
    v_pk_fma_f32 v[124:125], v[116:117], v[130:131], v[124:125] op_sel_hi:[1,0,1] neg_lo:[0,0,1] neg_hi:[0,0,1]
    v_pk_fma_f32 v[126:127], v[118:119], v[130:131], v[126:127] op_sel_hi:[1,0,1] neg_lo:[0,0,1] neg_hi:[0,0,1]
    v_cvt_pk_bf16_f32 v148, v120, v121
    v_cvt_pk_bf16_f32 v149, v122, v123
    v_cvt_pk_bf16_f32 v150, v124, v125
    v_cvt_pk_bf16_f32 v151, v126, v127
    s_waitcnt lgkmcnt(7)
    v_mfma_f32_32x32x16_bf16 v[48:63], v[40:43], v[144:147], v[48:63]
    ds_read_b128 v[40:43], v12 offset:224
    v_pk_fma_f32 v[96:97], v[104:105], v[130:131], v[96:97] op_sel_hi:[1,0,1] neg_lo:[0,0,1] neg_hi:[0,0,1]
    v_pk_fma_f32 v[98:99], v[106:107], v[130:131], v[98:99] op_sel_hi:[1,0,1] neg_lo:[0,0,1] neg_hi:[0,0,1]
    v_pk_fma_f32 v[100:101], v[108:109], v[130:131], v[100:101] op_sel_hi:[1,0,1] neg_lo:[0,0,1] neg_hi:[0,0,1]
    v_pk_fma_f32 v[102:103], v[110:111], v[130:131], v[102:103] op_sel_hi:[1,0,1] neg_lo:[0,0,1] neg_hi:[0,0,1]
    v_cvt_pk_bf16_f32 v136, v96, v97
    v_cvt_pk_bf16_f32 v137, v98, v99
    v_cvt_pk_bf16_f32 v138, v100, v101
    v_cvt_pk_bf16_f32 v139, v102, v103
    s_waitcnt lgkmcnt(7)
    v_mfma_f32_32x32x16_bf16 v[64:79], v[44:47], v[148:151], v[64:79]
    ds_read_b128 v[44:47], v13 offset:224
    v_pk_fma_f32 v[112:113], v[120:121], v[130:131], v[112:113] op_sel_hi:[1,0,1] neg_lo:[0,0,1] neg_hi:[0,0,1]
    v_pk_fma_f32 v[114:115], v[122:123], v[130:131], v[114:115] op_sel_hi:[1,0,1] neg_lo:[0,0,1] neg_hi:[0,0,1]
    v_pk_fma_f32 v[116:117], v[124:125], v[130:131], v[116:117] op_sel_hi:[1,0,1] neg_lo:[0,0,1] neg_hi:[0,0,1]
    v_pk_fma_f32 v[118:119], v[126:127], v[130:131], v[118:119] op_sel_hi:[1,0,1] neg_lo:[0,0,1] neg_hi:[0,0,1]
    v_cvt_pk_bf16_f32 v140, v112, v113
    v_cvt_pk_bf16_f32 v141, v114, v115
    v_cvt_pk_bf16_f32 v142, v116, v117
    v_cvt_pk_bf16_f32 v143, v118, v119
    s_waitcnt lgkmcnt(7)
    v_mfma_f32_32x32x16_bf16 v[48:63], v[16:19], v[136:139], v[48:63]
    ds_read_b128 v[16:19], v12 offset:256
    v_pk_fma_f32 v[104:105], v[96:97], v[130:131], v[104:105] op_sel_hi:[1,0,1] neg_lo:[0,0,1] neg_hi:[0,0,1]
    v_pk_fma_f32 v[106:107], v[98:99], v[130:131], v[106:107] op_sel_hi:[1,0,1] neg_lo:[0,0,1] neg_hi:[0,0,1]
    v_pk_fma_f32 v[108:109], v[100:101], v[130:131], v[108:109] op_sel_hi:[1,0,1] neg_lo:[0,0,1] neg_hi:[0,0,1]
    v_pk_fma_f32 v[110:111], v[102:103], v[130:131], v[110:111] op_sel_hi:[1,0,1] neg_lo:[0,0,1] neg_hi:[0,0,1]
    v_cvt_pk_bf16_f32 v144, v104, v105
    v_cvt_pk_bf16_f32 v145, v106, v107
    v_cvt_pk_bf16_f32 v146, v108, v109
    v_cvt_pk_bf16_f32 v147, v110, v111
    s_waitcnt lgkmcnt(7)
    v_mfma_f32_32x32x16_bf16 v[64:79], v[20:23], v[140:143], v[64:79]
    ds_read_b128 v[20:23], v13 offset:256
    v_pk_fma_f32 v[120:121], v[112:113], v[130:131], v[120:121] op_sel_hi:[1,0,1] neg_lo:[0,0,1] neg_hi:[0,0,1]
    v_pk_fma_f32 v[122:123], v[114:115], v[130:131], v[122:123] op_sel_hi:[1,0,1] neg_lo:[0,0,1] neg_hi:[0,0,1]
    v_pk_fma_f32 v[124:125], v[116:117], v[130:131], v[124:125] op_sel_hi:[1,0,1] neg_lo:[0,0,1] neg_hi:[0,0,1]
    v_pk_fma_f32 v[126:127], v[118:119], v[130:131], v[126:127] op_sel_hi:[1,0,1] neg_lo:[0,0,1] neg_hi:[0,0,1]
    v_cvt_pk_bf16_f32 v148, v120, v121
    v_cvt_pk_bf16_f32 v149, v122, v123
    v_cvt_pk_bf16_f32 v150, v124, v125
    v_cvt_pk_bf16_f32 v151, v126, v127
    s_waitcnt lgkmcnt(7)
    v_mfma_f32_32x32x16_bf16 v[48:63], v[24:27], v[144:147], v[48:63]
    ds_read_b128 v[24:27], v13 offset:288
    v_pk_fma_f32 v[96:97], v[104:105], v[130:131], v[96:97] op_sel_hi:[1,0,1] neg_lo:[0,0,1] neg_hi:[0,0,1]
    v_pk_fma_f32 v[98:99], v[106:107], v[130:131], v[98:99] op_sel_hi:[1,0,1] neg_lo:[0,0,1] neg_hi:[0,0,1]
    v_pk_fma_f32 v[100:101], v[108:109], v[130:131], v[100:101] op_sel_hi:[1,0,1] neg_lo:[0,0,1] neg_hi:[0,0,1]
    v_pk_fma_f32 v[102:103], v[110:111], v[130:131], v[102:103] op_sel_hi:[1,0,1] neg_lo:[0,0,1] neg_hi:[0,0,1]
    v_cvt_pk_bf16_f32 v136, v96, v97
    v_cvt_pk_bf16_f32 v137, v98, v99
    v_cvt_pk_bf16_f32 v138, v100, v101
    v_cvt_pk_bf16_f32 v139, v102, v103
    s_waitcnt lgkmcnt(7)
    v_mfma_f32_32x32x16_bf16 v[64:79], v[28:31], v[148:151], v[64:79]
    v_pk_fma_f32 v[112:113], v[120:121], v[130:131], v[112:113] op_sel_hi:[1,0,1] neg_lo:[0,0,1] neg_hi:[0,0,1]
    v_pk_fma_f32 v[114:115], v[122:123], v[130:131], v[114:115] op_sel_hi:[1,0,1] neg_lo:[0,0,1] neg_hi:[0,0,1]
    v_pk_fma_f32 v[116:117], v[124:125], v[130:131], v[116:117] op_sel_hi:[1,0,1] neg_lo:[0,0,1] neg_hi:[0,0,1]
    v_pk_fma_f32 v[118:119], v[126:127], v[130:131], v[118:119] op_sel_hi:[1,0,1] neg_lo:[0,0,1] neg_hi:[0,0,1]
    v_cvt_pk_bf16_f32 v140, v112, v113
    v_cvt_pk_bf16_f32 v141, v114, v115
    v_cvt_pk_bf16_f32 v142, v116, v117
    v_cvt_pk_bf16_f32 v143, v118, v119
    s_waitcnt lgkmcnt(6)
    v_mfma_f32_32x32x16_bf16 v[48:63], v[32:35], v[136:139], v[48:63]
    v_pk_fma_f32 v[104:105], v[96:97], v[130:131], v[104:105] op_sel_hi:[1,0,1] neg_lo:[0,0,1] neg_hi:[0,0,1]
    v_pk_fma_f32 v[106:107], v[98:99], v[130:131], v[106:107] op_sel_hi:[1,0,1] neg_lo:[0,0,1] neg_hi:[0,0,1]
    v_pk_fma_f32 v[108:109], v[100:101], v[130:131], v[108:109] op_sel_hi:[1,0,1] neg_lo:[0,0,1] neg_hi:[0,0,1]
    v_pk_fma_f32 v[110:111], v[102:103], v[130:131], v[110:111] op_sel_hi:[1,0,1] neg_lo:[0,0,1] neg_hi:[0,0,1]
    v_cvt_pk_bf16_f32 v144, v104, v105
    v_cvt_pk_bf16_f32 v145, v106, v107
    v_cvt_pk_bf16_f32 v146, v108, v109
    v_cvt_pk_bf16_f32 v147, v110, v111
    s_waitcnt lgkmcnt(5)
    v_mfma_f32_32x32x16_bf16 v[64:79], v[36:39], v[140:143], v[64:79]
    v_pk_fma_f32 v[120:121], v[112:113], v[130:131], v[120:121] op_sel_hi:[1,0,1] neg_lo:[0,0,1] neg_hi:[0,0,1]
    v_pk_fma_f32 v[122:123], v[114:115], v[130:131], v[122:123] op_sel_hi:[1,0,1] neg_lo:[0,0,1] neg_hi:[0,0,1]
    v_pk_fma_f32 v[124:125], v[116:117], v[130:131], v[124:125] op_sel_hi:[1,0,1] neg_lo:[0,0,1] neg_hi:[0,0,1]
    v_pk_fma_f32 v[126:127], v[118:119], v[130:131], v[126:127] op_sel_hi:[1,0,1] neg_lo:[0,0,1] neg_hi:[0,0,1]
    v_cvt_pk_bf16_f32 v148, v120, v121
    v_cvt_pk_bf16_f32 v149, v122, v123
    v_cvt_pk_bf16_f32 v150, v124, v125
    v_cvt_pk_bf16_f32 v151, v126, v127
    s_waitcnt lgkmcnt(4)
    v_mfma_f32_32x32x16_bf16 v[48:63], v[40:43], v[144:147], v[48:63]
    v_pk_fma_f32 v[96:97], v[104:105], v[130:131], v[96:97] op_sel_hi:[1,0,1] neg_lo:[0,0,1] neg_hi:[0,0,1]
    v_pk_fma_f32 v[98:99], v[106:107], v[130:131], v[98:99] op_sel_hi:[1,0,1] neg_lo:[0,0,1] neg_hi:[0,0,1]
    v_pk_fma_f32 v[100:101], v[108:109], v[130:131], v[100:101] op_sel_hi:[1,0,1] neg_lo:[0,0,1] neg_hi:[0,0,1]
    v_pk_fma_f32 v[102:103], v[110:111], v[130:131], v[102:103] op_sel_hi:[1,0,1] neg_lo:[0,0,1] neg_hi:[0,0,1]
    v_cvt_pk_bf16_f32 v136, v96, v97
    v_cvt_pk_bf16_f32 v137, v98, v99
    v_cvt_pk_bf16_f32 v138, v100, v101
    v_mul_f32 v134, v132, v103
    v_cvt_pk_bf16_f32 v139, v102, v134
    s_waitcnt lgkmcnt(3)
    v_mfma_f32_32x32x16_bf16 v[64:79], v[44:47], v[148:151], v[64:79]
    v_pk_fma_f32 v[112:113], v[120:121], v[130:131], v[112:113] op_sel_hi:[1,0,1] neg_lo:[0,0,1] neg_hi:[0,0,1]
    v_pk_fma_f32 v[114:115], v[122:123], v[130:131], v[114:115] op_sel_hi:[1,0,1] neg_lo:[0,0,1] neg_hi:[0,0,1]
    v_pk_fma_f32 v[116:117], v[124:125], v[130:131], v[116:117] op_sel_hi:[1,0,1] neg_lo:[0,0,1] neg_hi:[0,0,1]
    v_pk_fma_f32 v[118:119], v[126:127], v[130:131], v[118:119] op_sel_hi:[1,0,1] neg_lo:[0,0,1] neg_hi:[0,0,1]
    v_cvt_pk_bf16_f32 v140, v112, v113
    v_cvt_pk_bf16_f32 v141, v114, v115
    v_cvt_pk_bf16_f32 v142, v116, v117
    v_cvt_pk_bf16_f32 v143, v118, v119
    s_waitcnt lgkmcnt(2)
    v_mfma_f32_32x32x16_bf16 v[48:63], v[16:19], v[136:139], v[48:63]
    s_waitcnt lgkmcnt(1)
    v_mfma_f32_32x32x16_bf16 v[64:79], v[20:23], v[140:143], v[64:79]
    s_waitcnt lgkmcnt(0)
    v_mfma_f32_32x32x16_bf16 v[48:63], v[24:27], v[92:95], v[48:63]
    s_barrier
    s_nop 10
    v_pk_add_f32 v[16:17], v[48:49], v[64:65]
    v_pk_add_f32 v[32:33], v[48:49], v[64:65] neg_lo:[0,1] neg_hi:[0,1]
    v_pk_add_f32 v[18:19], v[50:51], v[66:67]
    v_pk_add_f32 v[34:35], v[50:51], v[66:67] neg_lo:[0,1] neg_hi:[0,1]
    v_pk_add_f32 v[20:21], v[52:53], v[68:69]
    v_pk_add_f32 v[36:37], v[52:53], v[68:69] neg_lo:[0,1] neg_hi:[0,1]
    v_pk_add_f32 v[22:23], v[54:55], v[70:71]
    v_pk_add_f32 v[38:39], v[54:55], v[70:71] neg_lo:[0,1] neg_hi:[0,1]
    v_pk_add_f32 v[24:25], v[56:57], v[72:73]
    v_pk_add_f32 v[40:41], v[56:57], v[72:73] neg_lo:[0,1] neg_hi:[0,1]
    v_pk_add_f32 v[26:27], v[58:59], v[74:75]
    v_pk_add_f32 v[42:43], v[58:59], v[74:75] neg_lo:[0,1] neg_hi:[0,1]
    v_pk_add_f32 v[28:29], v[60:61], v[76:77]
    v_pk_add_f32 v[44:45], v[60:61], v[76:77] neg_lo:[0,1] neg_hi:[0,1]
    v_pk_add_f32 v[30:31], v[62:63], v[78:79]
    v_pk_add_f32 v[46:47], v[62:63], v[78:79] neg_lo:[0,1] neg_hi:[0,1]
    v_cvt_pk_bf16_f32 v128, v16, v17
    v_cvt_pk_bf16_f32 v129, v18, v19
    v_cvt_pk_bf16_f32 v130, v20, v21
    v_cvt_pk_bf16_f32 v131, v22, v23
    v_cvt_pk_bf16_f32 v132, v24, v25
    v_cvt_pk_bf16_f32 v133, v26, v27
    v_cvt_pk_bf16_f32 v134, v28, v29
    v_cvt_pk_bf16_f32 v135, v30, v31
    v_cvt_pk_bf16_f32 v136, v32, v33
    v_cvt_pk_bf16_f32 v137, v34, v35
    v_cvt_pk_bf16_f32 v138, v36, v37
    v_cvt_pk_bf16_f32 v139, v38, v39
    v_cvt_pk_bf16_f32 v140, v40, v41
    v_cvt_pk_bf16_f32 v141, v42, v43
    v_cvt_pk_bf16_f32 v142, v44, v45
    v_cvt_pk_bf16_f32 v143, v46, v47
    s_branch L_s1_end
L_s1_skip:
    s_barrier
L_s1_end:
    v_add_u32 v160, s34, v14
    v_mov_b32 v164, 1073741824
    v_add_u32 v161, s35, v14
    v_mov_b32 v165, 1073741824
    v_add_u32 v162, s34, v15
    v_mov_b32 v166, 1073741824
    v_add_u32 v163, s35, v15
    v_mov_b32 v167, 1073741824
    s_cmp_lg_u32 s3, 11
    s_cbranch_scc1 L_fn1
    v_mov_b32 v3, 0
L_fnn:
    buffer_load_dword v4, v3, s[44:47], 0 offen sc1
    s_waitcnt vmcnt(0)
    v_readfirstlane_b32 s39, v4
    s_cmp_eq_u32 s39, 0
    s_cbranch_scc1 L_fnn
    v_mov_b32 v2, 159744
    s_mov_b64 exec, 1
    ds_write_b32 v2, v4 offset:100
    s_mov_b64 exec, -1
L_fn1:
    v_mov_b32 v3, 196608
    s_mov_b32 s27, 159744
    v_mov_b32 v4, 1
    v_writelane_b32 v3, s27, 0
    s_lshl_b32 s61, s24, 7
    s_add_u32 s61, s61, 14155776
    s_mov_b32 s60, 11
    s_cmp_lt_u32 s3, 8
    s_cselect_b32 s63, 3, 3
    s_cmp_ge_u32 s3, 4
    s_cbranch_scc1 L_fn2
    ds_add_u32 v3, v4 offset:80
L_fn2:
L_f_n:
    ds_read_b32 v5, v3 offset:100
    s_waitcnt lgkmcnt(0)
    v_readfirstlane_b32 s39, v5
    s_cmp_eq_u32 s39, 0
    s_cbranch_scc1 L_f_n
    s_cmp_lt_u32 s3, 8
    s_cbranch_scc1 L_attn
    s_branch L_h1
L_mw:
    s_setprio 2
    s_mov_b32 s56, 16384
    s_mov_b32 s57, -32768
    s_mov_b32 s58, -81920
    s_mov_b32 s59, 0x48
    s_and_b32 s26, s3, 1
    s_lshr_b32 s27, s3, 1
    s_lshl_b32 s38, s25, 1
    s_add_u32 s38, s38, s26
    v_and_b32 v2, 31, v1
    v_lshrrev_b32 v3, 5, v1
    v_lshrrev_b32 v4, 3, v2
    v_and_b32 v5, 7, v2
    v_lshlrev_b32 v5, 5, v5
    v_lshl_add_u32 v5, v4, 10, v5
    v_lshl_add_u32 v5, v3, 8, v5
    s_lshl_b32 s28, s27, 13
    v_add_u32 v5, s28, v5
    v_and_b32 v4, 1, v4
    v_lshl_add_u32 v8, v4, 4, v5
    v_xor_b32 v9, 16, v8
    v_bfe_u32 v4, v1, 2, 2
    v_lshl_add_u32 v5, v3, 3, v4
    v_lshlrev_b32 v5, 8, v5
    v_add_u32 v5, 49152, v5
    v_lshlrev_b32 v4, 6, v4
    s_lshl_b32 s28, s26, 7
    v_xor_b32 v4, s28, v4
    v_and_b32 v6, 3, v1
    v_bfe_u32 v7, v1, 4, 1
    v_lshl_add_u32 v6, v7, 2, v6
    v_lshlrev_b32 v6, 3, v6
    v_xor_b32 v7, v6, v4
    v_add_u32 v12, v7, v5
    v_xor_b32 v13, 64, v12
    s_mov_b32 s28, 159744
    v_mov_b32 v14, 196608
    v_mov_b32 v15, 1
    v_writelane_b32 v14, s28, 0
    s_lshl_b32 s30, s24, 1
    s_add_u32 s30, s30, s27
    s_lshl_b32 s61, s38, 5
    s_add_u32 s61, s61, s30
    s_lshl_b32 s61, s61, 8
    s_add_u32 s61, s61, 13631488
    s_lshr_b32 s63, s24, 2
    s_lshl_b32 s63, s63, 2
    s_lshr_b32 s63, 0x3320, s63
    s_and_b32 s63, s63, 15
    s_cmp_lt_u32 s38, 9
    s_cselect_b32 s63, 0, s63
    s_cmp_lt_u32 s38, 27
    s_cselect_b32 s63, s63, 255
    v_mov_b32 v64, 0
    v_mov_b32 v65, 0
    v_pk_mov_b32 v[66:67], v[64:65], v[64:65]
    v_pk_mov_b32 v[68:69], v[64:65], v[64:65]
    v_pk_mov_b32 v[70:71], v[64:65], v[64:65]
    v_pk_mov_b32 v[72:73], v[64:65], v[64:65]
    v_pk_mov_b32 v[74:75], v[64:65], v[64:65]
    v_pk_mov_b32 v[76:77], v[64:65], v[64:65]
    v_pk_mov_b32 v[78:79], v[64:65], v[64:65]
    v_pk_mov_b32 v[80:81], v[64:65], v[64:65]
    v_pk_mov_b32 v[82:83], v[64:65], v[64:65]
    v_pk_mov_b32 v[84:85], v[64:65], v[64:65]
    v_pk_mov_b32 v[86:87], v[64:65], v[64:65]
    v_pk_mov_b32 v[88:89], v[64:65], v[64:65]
    v_pk_mov_b32 v[90:91], v[64:65], v[64:65]
    v_pk_mov_b32 v[92:93], v[64:65], v[64:65]
    v_pk_mov_b32 v[94:95], v[64:65], v[64:65]
    v_pk_mov_b32 v[96:97], v[64:65], v[64:65]
    v_pk_mov_b32 v[98:99], v[64:65], v[64:65]
    v_pk_mov_b32 v[100:101], v[64:65], v[64:65]
    v_pk_mov_b32 v[102:103], v[64:65], v[64:65]
    v_pk_mov_b32 v[104:105], v[64:65], v[64:65]
    v_pk_mov_b32 v[106:107], v[64:65], v[64:65]
    v_pk_mov_b32 v[108:109], v[64:65], v[64:65]
    v_pk_mov_b32 v[110:111], v[64:65], v[64:65]
    v_pk_mov_b32 v[112:113], v[64:65], v[64:65]
    v_pk_mov_b32 v[114:115], v[64:65], v[64:65]
    v_pk_mov_b32 v[116:117], v[64:65], v[64:65]
    v_pk_mov_b32 v[118:119], v[64:65], v[64:65]
    v_pk_mov_b32 v[120:121], v[64:65], v[64:65]
    v_pk_mov_b32 v[122:123], v[64:65], v[64:65]
    v_pk_mov_b32 v[124:125], v[64:65], v[64:65]
    v_pk_mov_b32 v[126:127], v[64:65], v[64:65]
    s_cmp_ge_u32 s38, 18
    s_cbranch_scc1 L_p1_vsetup
    s_lshl_b32 s29, s38, 4
    s_lshl_b32 s37, s30, 9
    s_add_u32 s37, s37, 9437184
    s_lshl_b32 s31, s30, 11
    v_and_b32 v4, 15, v1
    v_add_u32 v4, s29, v4
    v_mul_u32_u24 v5, 3641, v4
    v_lshrrev_b32 v5, 15, v5
    v_mul_u32_u24 v6, 9, v5
    v_sub_u32 v6, v4, v6
    v_cmp_lt_u32 vcc, 4, v6
    v_subrev_u32 v7, 5, v6
    v_lshlrev_b32 v24, 1, v5
    v_cndmask_b32 v7, v6, v7, vcc
    v_addc_co_u32 v24, vcc, 0, v24, vcc
    v_mul_u32_u24 v24, 69888, v24
    v_lshl_add_u32 v24, v7, 9, v24
    v_cmp_eq_u32 vcc, 4, v6
    v_add_u32 v24, s31, v24
    v_lshl_add_u32 v5, v5, 14, s37
    v_cndmask_b32 v24, v24, v5, vcc
    v_lshlrev_b32 v23, 2, v3
    v_add_u32 v4, 0, v23
    ds_bpermute_b32 v160, v4, v24
    v_add_u32 v4, 8, v23
    ds_bpermute_b32 v161, v4, v24
    v_add_u32 v4, 16, v23
    ds_bpermute_b32 v162, v4, v24
    v_add_u32 v4, 24, v23
    ds_bpermute_b32 v163, v4, v24
    v_add_u32 v4, 32, v23
    ds_bpermute_b32 v164, v4, v24
    v_add_u32 v4, 40, v23
    ds_bpermute_b32 v165, v4, v24
    v_add_u32 v4, 48, v23
    ds_bpermute_b32 v166, v4, v24
    v_add_u32 v4, 56, v23
    ds_bpermute_b32 v167, v4, v24
    v_and_b32 v26, 0x13, v2
    v_bfe_u32 v7, v2, 2, 1
    v_lshl_or_b32 v26, v7, 3, v26
    v_bfe_u32 v7, v2, 3, 1
    v_lshl_or_b32 v26, v7, 2, v26
    v_lshlrev_b32 v26, 4, v26
    s_waitcnt lgkmcnt(0)
    v_add_u32 v160, v160, v26
    v_add_u32 v161, v161, v26
    v_add_u32 v162, v162, v26
    v_add_u32 v163, v163, v26
    v_add_u32 v164, v164, v26
    v_add_u32 v165, v165, v26
    v_add_u32 v166, v166, v26
    v_add_u32 v167, v167, v26
    s_mov_b32 s35, 0
    s_mov_b32 s34, 4
L_p1_qk_w:
    ds_read_b32 v7, v14 offset:0
    s_waitcnt lgkmcnt(0)
    v_readfirstlane_b32 s28, v7
    s_cmp_ge_u32 s28, 4
    s_cbranch_scc1 L_p1_qk_w_ok
    s_sleep 1
    s_branch L_p1_qk_w
L_p1_qk_w_ok:
    ds_read_b64_tr_b16 v[32:33], v12 offset:0
    ds_read_b64_tr_b16 v[34:35], v12 offset:1024
    ds_read_b128 v[40:43], v8 offset:0
    ds_read_b128 v[44:47], v8 offset:4096
    ds_read_b64_tr_b16 v[36:37], v13 offset:0
    ds_read_b64_tr_b16 v[38:39], v13 offset:1024
.p2align 6
L_p1_qk_loop:
    s_waitcnt lgkmcnt(3)
    v_mfma_f32_32x32x16_bf16 v[64:79], v[32:35], v[40:43], v[64:79]
    ds_read_b64_tr_b16 v[48:49], v12 offset:4096
    ds_read_b64_tr_b16 v[50:51], v12 offset:5120
    s_add_u32 s35, s35, 1
    s_bitcmp1_b32 s59, s35
    s_waitcnt lgkmcnt(4)
    v_mfma_f32_32x32x16_bf16 v[80:95], v[32:35], v[44:47], v[80:95]
    ds_read_b128 v[56:59], v8 offset:512
    ds_read_b128 v[60:63], v8 offset:4608
    s_cselect_b32 s29, s57, s56
    s_cmp_eq_u32 s35, 9
    s_waitcnt lgkmcnt(4)
    v_mfma_f32_32x32x16_bf16 v[96:111], v[36:39], v[40:43], v[96:111]
    ds_read_b64_tr_b16 v[52:53], v13 offset:4096
    ds_read_b64_tr_b16 v[54:55], v13 offset:5120
    s_cselect_b32 s34, 0, s34
    v_mfma_f32_32x32x16_bf16 v[112:127], v[36:39], v[44:47], v[112:127]
    s_waitcnt lgkmcnt(3)
    v_mfma_f32_32x32x16_bf16 v[64:79], v[48:51], v[56:59], v[64:79]
    ds_read_b64_tr_b16 v[32:33], v12 offset:8192
    ds_read_b64_tr_b16 v[34:35], v12 offset:9216
    s_waitcnt lgkmcnt(4)
    v_mfma_f32_32x32x16_bf16 v[80:95], v[48:51], v[60:63], v[80:95]
    ds_read_b128 v[40:43], v9 offset:0
    ds_read_b128 v[44:47], v9 offset:4096
    s_cmp_eq_u32 s35, 6
    s_cselect_b32 s60, s58, s56
    s_waitcnt lgkmcnt(4)
    v_mfma_f32_32x32x16_bf16 v[96:111], v[52:55], v[56:59], v[96:111]
    ds_read_b64_tr_b16 v[36:37], v13 offset:8192
    ds_read_b64_tr_b16 v[38:39], v13 offset:9216
    v_mfma_f32_32x32x16_bf16 v[112:127], v[52:55], v[60:63], v[112:127]
    s_waitcnt lgkmcnt(3)
    v_mfma_f32_32x32x16_bf16 v[64:79], v[32:35], v[40:43], v[64:79]
    ds_read_b32 v7, v14 offset:4
    ds_read_b64_tr_b16 v[48:49], v12 offset:12288
    ds_read_b64_tr_b16 v[50:51], v12 offset:13312
    s_waitcnt lgkmcnt(5)
    v_mfma_f32_32x32x16_bf16 v[80:95], v[32:35], v[44:47], v[80:95]
    ds_read_b128 v[56:59], v9 offset:512
    ds_read_b128 v[60:63], v9 offset:4608
    s_waitcnt lgkmcnt(5)
    v_mfma_f32_32x32x16_bf16 v[96:111], v[36:39], v[40:43], v[96:111]
    ds_read_b64_tr_b16 v[52:53], v13 offset:12288
    ds_read_b64_tr_b16 v[54:55], v13 offset:13312
    ds_add_u32 v14, v15 offset:48
    v_add_u32 v12, s60, v12
    v_add_u32 v13, s60, v13
    v_mfma_f32_32x32x16_bf16 v[112:127], v[36:39], v[44:47], v[112:127]
    v_add_u32 v8, s29, v8
    v_add_u32 v9, s29, v9
    s_waitcnt lgkmcnt(4)
    v_mfma_f32_32x32x16_bf16 v[64:79], v[48:51], v[56:59], v[64:79]
    v_readfirstlane_b32 s28, v7
    s_cmp_lt_u32 s28, s34
    s_cbranch_scc1 L_p1_qk_slow
L_p1_qk_go:
    ds_read_b64_tr_b16 v[32:33], v12 offset:0
    ds_read_b64_tr_b16 v[34:35], v12 offset:1024
    s_waitcnt lgkmcnt(5)
    v_mfma_f32_32x32x16_bf16 v[80:95], v[48:51], v[60:63], v[80:95]
    ds_read_b128 v[40:43], v8 offset:0
    ds_read_b128 v[44:47], v8 offset:4096
    s_waitcnt lgkmcnt(5)
    v_mfma_f32_32x32x16_bf16 v[96:111], v[52:55], v[56:59], v[96:111]
    ds_read_b64_tr_b16 v[36:37], v13 offset:0
    ds_read_b64_tr_b16 v[38:39], v13 offset:1024
    v_mfma_f32_32x32x16_bf16 v[112:127], v[52:55], v[60:63], v[112:127]
    v_add_u32 v14, 4, v14
    s_cmp_lt_u32 s35, 9
    s_cbranch_scc1 L_p1_qk_loop
    s_branch L_p1_qk_end
L_p1_qk_slow:
L_p1_qk_sl:
    ds_read_b32 v7, v14 offset:4
    s_waitcnt lgkmcnt(0)
    v_readfirstlane_b32 s28, v7
    s_cmp_ge_u32 s28, 4
    s_cbranch_scc0 L_p1_qk_sl
    s_branch L_p1_qk_go
L_p1_qk_end:
    v_cvt_pk_bf16_f32 v128, v64, v65
    v_cvt_pk_bf16_f32 v129, v66, v67
    v_cvt_pk_bf16_f32 v130, v80, v81
    v_cvt_pk_bf16_f32 v131, v82, v83
    v_cvt_pk_bf16_f32 v132, v68, v69
    v_cvt_pk_bf16_f32 v133, v70, v71
    v_cvt_pk_bf16_f32 v134, v84, v85
    v_cvt_pk_bf16_f32 v135, v86, v87
    v_cvt_pk_bf16_f32 v136, v72, v73
    v_cvt_pk_bf16_f32 v137, v74, v75
    v_cvt_pk_bf16_f32 v138, v88, v89
    v_cvt_pk_bf16_f32 v139, v90, v91
    v_cvt_pk_bf16_f32 v140, v76, v77
    v_cvt_pk_bf16_f32 v141, v78, v79
    v_cvt_pk_bf16_f32 v142, v92, v93
    v_cvt_pk_bf16_f32 v143, v94, v95
    v_cvt_pk_bf16_f32 v144, v96, v97
    v_cvt_pk_bf16_f32 v145, v98, v99
    v_cvt_pk_bf16_f32 v146, v112, v113
    v_cvt_pk_bf16_f32 v147, v114, v115
    v_cvt_pk_bf16_f32 v148, v100, v101
    v_cvt_pk_bf16_f32 v149, v102, v103
    v_cvt_pk_bf16_f32 v150, v116, v117
    v_cvt_pk_bf16_f32 v151, v118, v119
    v_cvt_pk_bf16_f32 v152, v104, v105
    v_cvt_pk_bf16_f32 v153, v106, v107
    v_cvt_pk_bf16_f32 v154, v120, v121
    v_cvt_pk_bf16_f32 v155, v122, v123
    v_cvt_pk_bf16_f32 v156, v108, v109
    v_cvt_pk_bf16_f32 v157, v110, v111
    v_cvt_pk_bf16_f32 v158, v124, v125
    v_cvt_pk_bf16_f32 v159, v126, v127
    s_branch L_p1_done
L_p1_vsetup:
    s_lshl_b32 s29, s38, 10
    s_mul_i32 s31, s30, 73728
    s_add_u32 s31, s31, s29
    s_add_u32 s31, s31, 5224448
    v_mul_u32_u24 v23, 9216, v3
    v_lshl_add_u32 v23, v2, 4, v23
    v_add_u32 v160, s31, v23
    v_add_u32 v161, 18432, v160
    v_add_u32 v162, 36864, v160
    v_add_u32 v163, 55296, v160
    v_add_u32 v164, 512, v160
    v_add_u32 v165, 18944, v160
    v_add_u32 v166, 37376, v160
    v_add_u32 v167, 55808, v160
    s_mov_b32 s35, 0
    s_mov_b32 s34, 4
L_p1_v_w:
    ds_read_b32 v7, v14 offset:0
    s_waitcnt lgkmcnt(0)
    v_readfirstlane_b32 s28, v7
    s_cmp_ge_u32 s28, 4
    s_cbranch_scc1 L_p1_v_w_ok
    s_sleep 1
    s_branch L_p1_v_w
L_p1_v_w_ok:
    ds_read_b64_tr_b16 v[32:33], v12 offset:0
    ds_read_b64_tr_b16 v[34:35], v12 offset:1024
    ds_read_b128 v[40:43], v8 offset:0
    ds_read_b128 v[44:47], v8 offset:4096
    ds_read_b64_tr_b16 v[36:37], v13 offset:0
    ds_read_b64_tr_b16 v[38:39], v13 offset:1024
.p2align 6
L_p1_v_loop:
    s_waitcnt lgkmcnt(3)
    v_mfma_f32_32x32x16_bf16 v[64:79], v[40:43], v[32:35], v[64:79]
    ds_read_b64_tr_b16 v[48:49], v12 offset:4096
    ds_read_b64_tr_b16 v[50:51], v12 offset:5120
    s_add_u32 s35, s35, 1
    s_bitcmp1_b32 s59, s35
    s_waitcnt lgkmcnt(4)
    v_mfma_f32_32x32x16_bf16 v[80:95], v[44:47], v[32:35], v[80:95]
    ds_read_b128 v[56:59], v8 offset:512
    ds_read_b128 v[60:63], v8 offset:4608
    s_cselect_b32 s29, s57, s56
    s_cmp_eq_u32 s35, 9
    s_waitcnt lgkmcnt(4)
    v_mfma_f32_32x32x16_bf16 v[96:111], v[40:43], v[36:39], v[96:111]
    ds_read_b64_tr_b16 v[52:53], v13 offset:4096
    ds_read_b64_tr_b16 v[54:55], v13 offset:5120
    s_cselect_b32 s34, 0, s34
    v_mfma_f32_32x32x16_bf16 v[112:127], v[44:47], v[36:39], v[112:127]
    s_waitcnt lgkmcnt(3)
    v_mfma_f32_32x32x16_bf16 v[64:79], v[56:59], v[48:51], v[64:79]
    ds_read_b64_tr_b16 v[32:33], v12 offset:8192
    ds_read_b64_tr_b16 v[34:35], v12 offset:9216
    s_waitcnt lgkmcnt(4)
    v_mfma_f32_32x32x16_bf16 v[80:95], v[60:63], v[48:51], v[80:95]
    ds_read_b128 v[40:43], v9 offset:0
    ds_read_b128 v[44:47], v9 offset:4096
    s_cmp_eq_u32 s35, 6
    s_cselect_b32 s60, s58, s56
    s_waitcnt lgkmcnt(4)
    v_mfma_f32_32x32x16_bf16 v[96:111], v[56:59], v[52:55], v[96:111]
    ds_read_b64_tr_b16 v[36:37], v13 offset:8192
    ds_read_b64_tr_b16 v[38:39], v13 offset:9216
    v_mfma_f32_32x32x16_bf16 v[112:127], v[60:63], v[52:55], v[112:127]
    s_waitcnt lgkmcnt(3)
    v_mfma_f32_32x32x16_bf16 v[64:79], v[40:43], v[32:35], v[64:79]
    ds_read_b32 v7, v14 offset:4
    ds_read_b64_tr_b16 v[48:49], v12 offset:12288
    ds_read_b64_tr_b16 v[50:51], v12 offset:13312
    s_waitcnt lgkmcnt(5)
    v_mfma_f32_32x32x16_bf16 v[80:95], v[44:47], v[32:35], v[80:95]
    ds_read_b128 v[56:59], v9 offset:512
    ds_read_b128 v[60:63], v9 offset:4608
    s_waitcnt lgkmcnt(5)
    v_mfma_f32_32x32x16_bf16 v[96:111], v[40:43], v[36:39], v[96:111]
    ds_read_b64_tr_b16 v[52:53], v13 offset:12288
    ds_read_b64_tr_b16 v[54:55], v13 offset:13312
    ds_add_u32 v14, v15 offset:48
    v_add_u32 v12, s60, v12
    v_add_u32 v13, s60, v13
    v_mfma_f32_32x32x16_bf16 v[112:127], v[44:47], v[36:39], v[112:127]
    v_add_u32 v8, s29, v8
    v_add_u32 v9, s29, v9
    s_waitcnt lgkmcnt(4)
    v_mfma_f32_32x32x16_bf16 v[64:79], v[56:59], v[48:51], v[64:79]
    v_readfirstlane_b32 s28, v7
    s_cmp_lt_u32 s28, s34
    s_cbranch_scc1 L_p1_v_slow
L_p1_v_go:
    ds_read_b64_tr_b16 v[32:33], v12 offset:0
    ds_read_b64_tr_b16 v[34:35], v12 offset:1024
    s_waitcnt lgkmcnt(5)
    v_mfma_f32_32x32x16_bf16 v[80:95], v[60:63], v[48:51], v[80:95]
    ds_read_b128 v[40:43], v8 offset:0
    ds_read_b128 v[44:47], v8 offset:4096
    s_waitcnt lgkmcnt(5)
    v_mfma_f32_32x32x16_bf16 v[96:111], v[56:59], v[52:55], v[96:111]
    ds_read_b64_tr_b16 v[36:37], v13 offset:0
    ds_read_b64_tr_b16 v[38:39], v13 offset:1024
    v_mfma_f32_32x32x16_bf16 v[112:127], v[60:63], v[52:55], v[112:127]
    v_add_u32 v14, 4, v14
    s_cmp_lt_u32 s35, 9
    s_cbranch_scc1 L_p1_v_loop
    s_branch L_p1_v_end
L_p1_v_slow:
L_p1_v_sl:
    ds_read_b32 v7, v14 offset:4
    s_waitcnt lgkmcnt(0)
    v_readfirstlane_b32 s28, v7
    s_cmp_ge_u32 s28, 4
    s_cbranch_scc0 L_p1_v_sl
    s_branch L_p1_v_go
L_p1_v_end:
    v_cvt_pk_bf16_f32 v128, v64, v65
    v_cvt_pk_bf16_f32 v129, v66, v67
    v_cvt_pk_bf16_f32 v130, v68, v69
    v_cvt_pk_bf16_f32 v131, v70, v71
    v_cvt_pk_bf16_f32 v132, v72, v73
    v_cvt_pk_bf16_f32 v133, v74, v75
    v_cvt_pk_bf16_f32 v134, v76, v77
    v_cvt_pk_bf16_f32 v135, v78, v79
    v_cvt_pk_bf16_f32 v136, v80, v81
    v_cvt_pk_bf16_f32 v137, v82, v83
    v_cvt_pk_bf16_f32 v138, v84, v85
    v_cvt_pk_bf16_f32 v139, v86, v87
    v_cvt_pk_bf16_f32 v140, v88, v89
    v_cvt_pk_bf16_f32 v141, v90, v91
    v_cvt_pk_bf16_f32 v142, v92, v93
    v_cvt_pk_bf16_f32 v143, v94, v95
    v_cvt_pk_bf16_f32 v144, v96, v97
    v_cvt_pk_bf16_f32 v145, v98, v99
    v_cvt_pk_bf16_f32 v146, v100, v101
    v_cvt_pk_bf16_f32 v147, v102, v103
    v_cvt_pk_bf16_f32 v148, v104, v105
    v_cvt_pk_bf16_f32 v149, v106, v107
    v_cvt_pk_bf16_f32 v150, v108, v109
    v_cvt_pk_bf16_f32 v151, v110, v111
    v_cvt_pk_bf16_f32 v152, v112, v113
    v_cvt_pk_bf16_f32 v153, v114, v115
    v_cvt_pk_bf16_f32 v154, v116, v117
    v_cvt_pk_bf16_f32 v155, v118, v119
    v_cvt_pk_bf16_f32 v156, v120, v121
    v_cvt_pk_bf16_f32 v157, v122, v123
    v_cvt_pk_bf16_f32 v158, v124, v125
    v_cvt_pk_bf16_f32 v159, v126, v127
L_p1_done:
    s_cmp_lg_u32 s63, 0
    s_cbranch_scc1 L_h0a_s
    buffer_store_dwordx4 v[128:131], v160, s[8:11], 0 offen sc1
    buffer_store_dwordx4 v[132:135], v161, s[8:11], 0 offen sc1
    buffer_store_dwordx4 v[136:139], v162, s[8:11], 0 offen sc1
    buffer_store_dwordx4 v[140:143], v163, s[8:11], 0 offen sc1
    buffer_store_dwordx4 v[144:147], v164, s[8:11], 0 offen sc1
    buffer_store_dwordx4 v[148:151], v165, s[8:11], 0 offen sc1
    buffer_store_dwordx4 v[152:155], v166, s[8:11], 0 offen sc1
    buffer_store_dwordx4 v[156:159], v167, s[8:11], 0 offen sc1
L_h0a_s:
    v_mov_b32 v14, 159744
    s_mov_b32 s60, 0
L_m_n:
    ds_read_b32 v5, v14 offset:100
    s_waitcnt lgkmcnt(0)
    v_readfirstlane_b32 s39, v5
    s_cmp_eq_u32 s39, 0
    s_cbranch_scc1 L_m_n
    s_cmp_lg_u32 s63, 0
    s_cbranch_scc1 L_h0b_f
    s_waitcnt vmcnt(0)
    s_cmp_eq_u32 s60, 0
    s_cbranch_scc1 L_h0b_d
    ds_add_rtn_u32 v5, v14, v15 offset:96
    s_waitcnt lgkmcnt(0)
    v_readfirstlane_b32 s30, v5
    s_cmp_lg_u32 s30, s60
    s_cbranch_scc1 L_h0b_f
L_h0b_d:
    v_mov_b32 v5, s39
    s_mov_b64 exec, 1
    buffer_store_dword v5, off, s[8:11], s61 sc1
    s_mov_b64 exec, -1
L_h0b_f:
L_attn:
    s_memtime s[24:25]
    s_memrealtime s[26:27]
    s_lshr_b32 s28, s3, 2
    s_cmp_eq_u32 s28, 1
    s_mov_b32 s28, 1171144704
    s_cselect_b32 s28, s28, 1176461312
    s_waitcnt lgkmcnt(0)
    s_sub_u32 s24, s24, s20
    s_sub_u32 s26, s26, s7
    v_cvt_f32_u32 v32, s24
    v_cvt_f32_u32 v33, s26
    v_rcp_f32 v32, v32
    s_nop 0
    v_mul_f32 v32, v32, v33
    v_mul_f32 v33, s28, v32
    v_mul_f32 v32, s29, v32
    v_cvt_u32_f32 v33, v33
    v_cvt_u32_f32 v32, v32
    v_readfirstlane_b32 s57, v33
    v_readfirstlane_b32 s58, v32
    s_and_b32 s23, s3, 3
    s_lshr_b32 s24, s3, 2
    s_add_u32 s25, s23, 8
    s_add_u32 s23, s23, 4
    s_cmp_eq_u32 s24, 1
    s_cselect_b32 s23, s23, s25
    s_lshr_b32 s53, s23, 3
    s_lshr_b32 s27, s23, 2
    s_and_b32 s30, s23, 1
    s_cmp_ge_u32 s23, 8
    s_cselect_b32 s27, s30, s27
    s_sub_u32 s30, s23, 8
    s_cmp_ge_u32 s23, 10
    s_cselect_b32 s53, s30, s53
    s_and_b32 s33, s23, 3
    v_lshlrev_b32 v100, 4, v1
    v_mov_b32 v101, 196608
    s_mov_b32 s28, 159744
    v_writelane_b32 v101, s28, 0
    s_lshl_b32 s5, s27, 2
    v_lshlrev_b32 v104, 2, v1
    v_add_u32 v104, 160000, v104
    v_lshrrev_b32 v32, 4, v1
    s_lshr_b32 s24, s21, 2
    s_lshl_b32 s24, s24, 3
    s_and_b32 s30, s21, 3
    s_add_u32 s24, s24, s30
    s_lshl_b32 s24, s24, 1
    s_add_u32 s24, s24, s27
    s_and_b32 s30, s53, 1
    s_xor_b32 s30, s30, 0
    s_lshl_b32 s30, s30, 3
    s_add_u32 s24, s24, s30
    s_mul_i32 s24, s24, 36864
    s_mul_i32 s25, s22, 144
    s_add_u32 s24, s24, s25
    s_add_u32 s48, s24, 1152
    s_mul_i32 s28, s27, 13824
    s_add_u32 s28, s28, 100352
    s_mul_i32 s32, s27, 4608
    s_add_u32 s32, s32, 143360
    s_mul_i32 s51, s27, 78848
    s_add_u32 s51, s51, 49152
    s_cmp_eq_u32 s53, 0
    s_cselect_b32 s51, s51, s28
    s_cselect_b32 s33, s33, 3
    s_mul_i32 s30, s33, 4608
    s_add_u32 s28, s28, s30
    s_mul_i32 s34, s33, 5
    s_cmp_eq_u32 s33, 3
    s_cselect_b32 s6, s32, s28
    s_cselect_b32 s34, 14, s34
    s_cmp_lt_u32 s33, 2
    s_cselect_b32 s52, 0, 0x0101
    s_cselect_b32 s35, 0, 24576
    s_and_b32 s30, s52, 1
    s_sub_u32 s34, s34, s30
    s_mov_b32 s20, s34
    s_lshl_b32 s26, s21, 2
    s_add_u32 s26, s26, s27
    s_mul_i32 s26, s26, 18
    s_add_u32 s26, s26, s34
    s_lshl_b32 s26, s26, 10
    s_add_u32 s49, s26, 10485760
    s_add_u32 s50, s49, 36864
    s_lshl_b32 s30, s34, 12
    s_add_u32 s35, s35, s30
    v_bfe_u32 v33, v1, 2, 2
    v_lshl_add_u32 v34, v32, 3, v33
    v_and_b32 v35, 3, v1
    v_lshrrev_b32 v33, 1, v33
    v_and_b32 v32, 1, v32
    v_lshl_or_b32 v33, v32, 1, v33
    v_lshlrev_b32 v36, 7, v34
    v_lshl_add_u32 v36, v35, 3, v36
    v_add_u32 v36, s35, v36
    v_xor_b32 v32, 0, v33
    v_lshl_add_u32 v110, v32, 5, v36
    v_xor_b32 v32, 1, v33
    v_lshl_add_u32 v114, v32, 5, v36
    v_xor_b32 v32, 2, v33
    v_lshl_add_u32 v118, v32, 5, v36
    v_xor_b32 v32, 3, v33
    v_lshl_add_u32 v122, v32, 5, v36
    v_and_b32 v35, 1, v35
    v_lshlrev_b32 v35, 3, v35
    v_lshl_add_u32 v35, v34, 4, v35
    s_lshl_b32 s28, s34, 9
    s_add_u32 s28, s28, 40960
    s_cmp_eq_u32 s33, 3
    s_cselect_b32 s28, 97792, s28
    v_add_u32 v126, s28, v35
    s_mov_b32 s12, s42
    s_mov_b32 s13, s43
    s_mov_b32 s14, 4718592
    s_mov_b32 s15, 0x00020000
    v_and_b32 v99, 0x13, v1
    v_bfe_u32 v107, v1, 2, 1
    v_lshl_or_b32 v99, v107, 3, v99
    v_bfe_u32 v107, v1, 3, 1
    v_lshl_or_b32 v99, v107, 2, v99
    v_lshrrev_b32 v107, 4, v99
    v_mul_u32_u24 v107, 18432, v107
    v_and_b32 v99, 15, v99
    v_lshl_add_u32 v99, v99, 4, v107
    v_lshrrev_b32 v107, 5, v1
    v_lshl_add_u32 v107, v107, 8, v99
    s_and_b32 s36, s3, 3
    s_lshl_b32 s36, s36, 1
    s_lshr_b32 s54, s3, 2
    s_xor_b32 s54, s54, 1
    s_add_u32 s36, s36, s54
    s_lshl_b32 s54, s22, 3
    s_add_u32 s36, s36, s54
    s_lshl_b32 s56, s36, 5
    s_add_u32 s56, s56, s21
    s_lshl_b32 s56, s56, 8
    s_add_u32 s56, s56, 13107200
    s_mul_i32 s36, s36, 36864
    s_add_u32 s36, s36, 10485760
    s_lshl_b32 s54, s21, 9
    s_add_u32 s54, s54, s36
    s_lshr_b32 s55, s21, 2
    s_lshl_b32 s55, s55, 8
    s_add_u32 s55, s55, s36
    s_and_b32 s37, s21, 3
    s_lshl_b32 s37, s37, 2
    s_add_u32 s55, s55, s37
    s_add_u32 s55, s55, 16384
    s_mul_i32 s26, s21, 18
    s_and_b32 s27, s21, 1
    s_lshl_b32 s27, s27, 1
    s_sub_u32 s26, s26, s27
    s_add_u32 s27, s26, 19
    s_add_u32 s26, s26, 0
    s_lshr_b32 s26, s26, 6
    s_lshr_b32 s27, s27, 6
    s_lshl_b32 s26, s26, 13
    s_lshl_b32 s27, s27, 13
    v_mov_b32 v2, s26
    v_writelane_b32 v2, s27, 0
    s_lshl_b32 s25, s22, 3
    s_add_u32 s25, s25, s3
    s_lshr_b32 s34, s25, 1
    s_lshl_b32 s29, s34, 8
    s_add_u32 s29, s29, 13631488
    s_and_b32 s35, s25, 1
    s_lshl_b32 s35, s35, 3
    s_mul_i32 s24, s21, 69888
    s_lshl_b32 s26, s34, 11
    s_add_u32 s24, s24, s26
    s_add_u32 s24, s24, s35
    s_lshr_b32 s26, s21, 1
    s_lshl_b32 s26, s26, 14
    s_lshl_b32 s27, s34, 9
    s_add_u32 s26, s26, s27
    s_and_b32 s27, s21, 1
    s_lshl_b32 s28, s27, 2
    s_add_u32 s26, s26, s28
    s_add_u32 s26, s26, s35
    s_add_u32 s26, s26, 9437184
    v_and_b32 v3, 31, v1
    v_lshrrev_b32 v29, 5, v1
    v_lshlrev_b32 v98, 4, v3
    v_lshl_add_u32 v97, v29, 10, v98
    v_mov_b32 v27, 0xdddd
    v_mul_u32_u24 v29, 19, v29
    v_add_u32 v29, v29, v3
    v_lshlrev_b32 v29, 4, v29
    v_add_u32 v26, 65536, v29
    v_cmp_lt_u32 vcc, 18, v3
    v_mov_b32 v29, 196608
    v_mov_b32 v96, 196608
    s_mov_b32 s28, 159744
    v_cndmask_b32 v26, v26, v29, vcc
    v_writelane_b32 v96, s28, 0
    v_lshrrev_b32 v3, 1, v3
    v_and_b32 v3, 8, v3
    v_mov_b32 v31, 1
    v_mov_b32 v64, 0
    v_mov_b32 v65, 0
    v_mov_b32 v66, 0
    v_mov_b32 v67, 0
    v_mov_b32 v68, 0
    v_mov_b32 v69, 0
    v_mov_b32 v70, 0
    v_mov_b32 v71, 0
    v_mov_b32 v72, 0
    v_mov_b32 v73, 0
    v_mov_b32 v74, 0
    v_mov_b32 v75, 0
    v_mov_b32 v76, 0
    v_mov_b32 v77, 0
    v_mov_b32 v78, 0
    v_mov_b32 v79, 0
    v_mov_b32 v56, 0
    v_mov_b32 v57, 0
    v_mov_b32 v58, 0
    v_mov_b32 v59, 0
    v_mov_b32 v60, 0
    v_mov_b32 v61, 0
    v_mov_b32 v62, 0
    v_mov_b32 v63, 0
    s_cmp_lt_u32 s3, 4
    s_cbranch_scc1 L_p2_qd
L_p2_qf:
    ds_read_b32 v30, v96 offset:80
    s_waitcnt lgkmcnt(0)
    v_readfirstlane_b32 s30, v30
    s_cmp_ge_u32 s30, 4
    s_cbranch_scc1 L_p2_qf_ok
    s_sleep 4
    s_branch L_p2_qf
L_p2_qf_ok:
    s_sleep 16
L_p2_qd:
L_p2_qp:
    buffer_load_dword v30, v2, s[8:11], s29 offen sc1
    s_waitcnt vmcnt(0)
    v_cmp_eq_u32 vcc, s39, v30
    s_cmp_eq_u64 vcc, -1
    s_cbranch_scc1 L_p2_qp_ok
    s_sleep 4
    s_branch L_p2_qp
L_p2_qp_ok:
    buffer_load_dwordx2 v[4:5], v97, s[8:11], s24 offen sc1
    buffer_load_dwordx2 v[6:7], v97, s[8:11], s24 offen offset:512 sc1
    buffer_load_dword v8, v98, s[8:11], s26 offen sc1
    v_or_b32 v24, v97, v3
    v_or_b32 v25, v98, v3
    v_add_u32 v25, 143360, v25
    v_cmp_gt_u32 vcc, 32, v1
    s_mov_b32 s28, 1051597459
    s_cmp_eq_u32 s27, 0
    v_mov_b32 v29, 160768
    v_mov_b32 v81, 2048
    v_cndmask_b32 v25, v29, v25, vcc
    v_cndmask_b32 v80, 0, v81, vcc
    s_cselect_b64 s[34:35], vcc, 0
    s_cselect_b64 s[32:33], 0, vcc
    s_cmp_lg_u32 s63, 1
    s_cbranch_scc1 L_p2_q0
    s_cmp_lg_u32 s63, 1
    s_cbranch_scc1 L_h1_s
    buffer_store_dwordx4 v[128:131], v160, s[8:11], 0 offen sc1
    buffer_store_dwordx4 v[132:135], v161, s[8:11], 0 offen sc1
    buffer_store_dwordx4 v[136:139], v162, s[8:11], 0 offen sc1
    buffer_store_dwordx4 v[140:143], v163, s[8:11], 0 offen sc1
    buffer_store_dwordx4 v[144:147], v164, s[8:11], 0 offen sc1
    buffer_store_dwordx4 v[148:151], v165, s[8:11], 0 offen sc1
    buffer_store_dwordx4 v[152:155], v166, s[8:11], 0 offen sc1
    buffer_store_dwordx4 v[156:159], v167, s[8:11], 0 offen sc1
L_h1_s:
    s_waitcnt vmcnt(8)
    s_branch L_p2_q1
L_p2_q0:
    s_waitcnt vmcnt(0)
L_p2_q1:
    v_xor_b32 v97, 8, v24
    v_xor_b32 v98, 8, v25
    v_lshlrev_b32 v29, 16, v4
    v_and_b32 v30, 0xffff0000, v4
    v_mul_f32 v29, s28, v29
    v_mul_f32 v30, s28, v30
    v_cvt_pk_bf16_f32 v4, v29, v30
    v_lshlrev_b32 v29, 16, v5
    v_and_b32 v30, 0xffff0000, v5
    v_mul_f32 v29, s28, v29
    v_mul_f32 v30, s28, v30
    v_cvt_pk_bf16_f32 v5, v29, v30
    v_lshlrev_b32 v29, 16, v6
    v_and_b32 v30, 0xffff0000, v6
    v_mul_f32 v29, s28, v29
    v_mul_f32 v30, s28, v30
    v_cvt_pk_bf16_f32 v6, v29, v30
    v_lshlrev_b32 v29, 16, v7
    v_and_b32 v30, 0xffff0000, v7
    v_mul_f32 v29, s28, v29
    v_mul_f32 v30, s28, v30
    v_cvt_pk_bf16_f32 v7, v29, v30
    v_lshlrev_b32 v29, 16, v8
    v_and_b32 v30, 0xffff0000, v8
    v_mul_f32 v29, s28, v29
    v_mul_f32 v30, s28, v30
    v_cvt_pk_bf16_f32 v8, v29, v30
    v_cndmask_b32 v9, 0, v8, s[32:33]
    v_cndmask_b32 v8, 0, v8, s[34:35]
L_p2_w1:
    ds_read_b32 v30, v96 offset:164
    s_waitcnt lgkmcnt(0)
    v_readfirstlane_b32 s30, v30
    s_cmp_ge_u32 s30, 4
    s_cbranch_scc1 L_p2_w1_ok
    s_sleep 1
    s_branch L_p2_w1
L_p2_w1_ok:
L_p2_w0:
    ds_read_b32 v30, v96 offset:104
    s_waitcnt lgkmcnt(0)
    v_readfirstlane_b32 s30, v30
    s_andn2_b32 s31, 3, s30
    s_cbranch_scc0 L_p2_w0_ok
    s_sleep 1
    s_branch L_p2_w0
L_p2_w0_ok:
    ds_read_b64 v[10:11], v25 offset:0
    ds_read2st64_b64 v[12:15], v24 offset0:0 offset1:1
    s_waitcnt lgkmcnt(0)
    v_mfma_f32_32x32x8_bf16 v[32:47], v[10:11], v[8:9], 0
    v_mfma_f32_32x32x16_bf16 v[32:47], v[12:15], v[4:7], v[32:47]
    ds_read_b128 v[20:23], v26 offset:1824
    ds_read_b64 v[10:11], v98 offset:0
    ds_read2st64_b64 v[12:15], v97 offset0:0 offset1:1
    ds_read_b128 v[16:19], v26 offset:0
    s_mov_b32 s27, 0
    s_mov_b32 s29, 0x03800000
    s_mov_b32 s28, 0x7f
    s_mov_b32 s38, 15
    s_setprio 1
    s_mov_b64 vcc, -1
    s_nop 1
    v_max3_f32 v28, v32, v33, v34
    v_max3_f32 v28, v28, v35, v36
    v_max3_f32 v28, v28, v37, v38
    v_max3_f32 v28, v28, v39, v40
    v_max3_f32 v28, v28, v41, v42
    v_max3_f32 v28, v28, v43, v44
    v_max3_f32 v28, v28, v45, v46
    v_max_f32 v28, v28, v47
    v_mov_b32 v29, v28
    s_nop 1
    v_permlane32_swap_b32 v28, v29
    s_nop 1
    v_max_f32 v28, v28, v29
    v_sub_f32 v28, -100.0, v28
    v_and_b32 v28, 0xffff0000, v28
    v_lshrrev_b32 v29, 16, v28
    s_mov_b32 exec_lo, 0
    v_mov_b32 v8, v29
    s_mov_b32 exec_lo, -1
    v_add_f32 v32, v32, v28
    v_add_f32 v33, v33, v28
    v_add_f32 v34, v34, v28
    v_add_f32 v35, v35, v28
    v_add_f32 v36, v36, v28
    v_add_f32 v37, v37, v28
    v_add_f32 v38, v38, v28
    v_add_f32 v39, v39, v28
    v_add_f32 v40, v40, v28
    v_add_f32 v41, v41, v28
    v_add_f32 v42, v42, v28
    v_add_f32 v43, v43, v28
    v_add_f32 v44, v44, v28
    v_add_f32 v45, v45, v28
    v_add_f32 v46, v46, v28
    v_add_f32 v47, v47, v28
    s_cmp_lg_u32 s63, 1
    s_cbranch_scc1 L_h2a_f
    s_waitcnt vmcnt(0)
    s_cmp_eq_u32 s60, 0
    s_cbranch_scc1 L_h2a_d
    ds_add_rtn_u32 v30, v96, v31 offset:96
    s_waitcnt lgkmcnt(0)
    v_readfirstlane_b32 s30, v30
    s_cmp_lg_u32 s30, s60
    s_cbranch_scc1 L_h2a_f
L_h2a_d:
    v_mov_b32 v30, s39
    s_mov_b64 exec, 1
    buffer_store_dword v30, off, s[8:11], s61 sc1
    s_mov_b64 exec, -1
L_h2a_f:
    s_cmp_lg_u32 s63, 2
    s_cbranch_scc1 L_h2b_s
    buffer_store_dwordx4 v[128:131], v160, s[8:11], 0 offen sc1
    buffer_store_dwordx4 v[132:135], v161, s[8:11], 0 offen sc1
    buffer_store_dwordx4 v[136:139], v162, s[8:11], 0 offen sc1
    buffer_store_dwordx4 v[140:143], v163, s[8:11], 0 offen sc1
    buffer_store_dwordx4 v[144:147], v164, s[8:11], 0 offen sc1
    buffer_store_dwordx4 v[148:151], v165, s[8:11], 0 offen sc1
    buffer_store_dwordx4 v[152:155], v166, s[8:11], 0 offen sc1
    buffer_store_dwordx4 v[156:159], v167, s[8:11], 0 offen sc1
L_h2b_s:
.p2align 6
L_p2_loop:
    v_exp_f32 v32, v32
    v_exp_f32 v33, v33
    s_waitcnt lgkmcnt(3)
    v_smfmac_f32_32x32x32_bf16 v[64:79], v[20:23], v[56:63], v27
    ds_read_b128 v[20:23], v26 offset:1824
    v_exp_f32 v34, v34
    v_exp_f32 v35, v35
    v_exp_f32 v36, v36
    v_exp_f32 v37, v37
    s_waitcnt lgkmcnt(3)
    v_mfma_f32_32x32x8_bf16 v[48:63], v[10:11], v[8:9], 0
    ds_read_b64 v[10:11], v25 offset:512
    v_exp_f32 v38, v38
    v_exp_f32 v39, v39
    v_exp_f32 v40, v40
    v_exp_f32 v41, v41
    s_waitcnt lgkmcnt(3)
    v_mfma_f32_32x32x16_bf16 v[48:63], v[12:15], v[4:7], v[48:63]
    ds_read2st64_b64 v[12:15], v24 offset0:4 offset1:5
    v_exp_f32 v42, v42
    v_exp_f32 v43, v43
    v_exp_f32 v44, v44
    v_exp_f32 v45, v45
    s_waitcnt lgkmcnt(3)
    v_smfmac_f32_32x32x32_bf16 v[64:79], v[16:19], v[32:39], v27
    ds_read_b128 v[16:19], v26 offset:1216
    v_exp_f32 v46, v46
    v_exp_f32 v47, v47
    v_exp_f32 v48, v48
    v_exp_f32 v49, v49
    s_waitcnt lgkmcnt(3)
    v_smfmac_f32_32x32x32_bf16 v[64:79], v[20:23], v[40:47], v27
    ds_read_b128 v[20:23], v26 offset:608
    v_exp_f32 v50, v50
    v_exp_f32 v51, v51
    v_exp_f32 v52, v52
    v_exp_f32 v53, v53
    s_waitcnt lgkmcnt(3)
    v_mfma_f32_32x32x8_bf16 v[32:47], v[10:11], v[8:9], 0
    ds_read_b64 v[10:11], v98 offset:512
    v_exp_f32 v54, v54
    v_exp_f32 v55, v55
    v_exp_f32 v56, v56
    v_exp_f32 v57, v57
    s_waitcnt lgkmcnt(3)
    v_mfma_f32_32x32x16_bf16 v[32:47], v[12:15], v[4:7], v[32:47]
    ds_read2st64_b64 v[12:15], v97 offset0:4 offset1:5
    v_exp_f32 v58, v58
    v_exp_f32 v59, v59
    v_exp_f32 v60, v60
    v_exp_f32 v61, v61
    s_waitcnt lgkmcnt(3)
    v_smfmac_f32_32x32x32_bf16 v[64:79], v[16:19], v[48:55], v27
    ds_read_b128 v[16:19], v26 offset:2432
    v_exp_f32 v62, v62
    v_exp_f32 v63, v63
    v_exp_f32 v32, v32
    v_exp_f32 v33, v33
    s_waitcnt lgkmcnt(3)
    v_smfmac_f32_32x32x32_bf16 v[64:79], v[20:23], v[56:63], v27
    ds_read_b128 v[20:23], v26 offset:4256
    v_exp_f32 v34, v34
    v_exp_f32 v35, v35
    v_exp_f32 v36, v36
    v_exp_f32 v37, v37
    s_waitcnt lgkmcnt(3)
    v_mfma_f32_32x32x8_bf16 v[48:63], v[10:11], v[8:9], 0
    ds_read_b64 v[10:11], v25 offset:1024
    v_exp_f32 v38, v38
    v_exp_f32 v39, v39
    v_exp_f32 v40, v40
    v_exp_f32 v41, v41
    s_waitcnt lgkmcnt(3)
    v_mfma_f32_32x32x16_bf16 v[48:63], v[12:15], v[4:7], v[48:63]
    ds_read2st64_b64 v[12:15], v24 offset0:8 offset1:9
    v_exp_f32 v42, v42
    v_exp_f32 v43, v43
    v_exp_f32 v44, v44
    v_exp_f32 v45, v45
    s_waitcnt lgkmcnt(3)
    v_smfmac_f32_32x32x32_bf16 v[64:79], v[16:19], v[32:39], v27
    ds_read_b128 v[16:19], v26 offset:3648
    v_exp_f32 v46, v46
    v_exp_f32 v47, v47
    s_cbranch_vccnz L_p2_pr3
    s_setprio 0
L_p2_pr3:
    v_exp_f32 v48, v48
    v_exp_f32 v49, v49
    s_waitcnt lgkmcnt(3)
    v_smfmac_f32_32x32x32_bf16 v[64:79], v[20:23], v[40:47], v27
    ds_read_b128 v[20:23], v26 offset:3040
    v_exp_f32 v50, v50
    v_exp_f32 v51, v51
    v_exp_f32 v52, v52
    v_exp_f32 v53, v53
    s_waitcnt lgkmcnt(3)
    v_mfma_f32_32x32x8_bf16 v[32:47], v[10:11], v[8:9], 0
    ds_read_b64 v[10:11], v98 offset:1024
    v_exp_f32 v54, v54
    v_exp_f32 v55, v55
    v_exp_f32 v56, v56
    v_exp_f32 v57, v57
    s_waitcnt lgkmcnt(3)
    v_mfma_f32_32x32x16_bf16 v[32:47], v[12:15], v[4:7], v[32:47]
    ds_read2st64_b64 v[12:15], v97 offset0:8 offset1:9
    v_exp_f32 v58, v58
    v_exp_f32 v59, v59
    v_exp_f32 v60, v60
    v_exp_f32 v61, v61
    s_waitcnt lgkmcnt(3)
    v_smfmac_f32_32x32x32_bf16 v[64:79], v[16:19], v[48:55], v27
    ds_read_b128 v[16:19], v26 offset:4864
    v_exp_f32 v62, v62
    v_exp_f32 v63, v63
    v_exp_f32 v32, v32
    v_exp_f32 v33, v33
    s_waitcnt lgkmcnt(3)
    v_smfmac_f32_32x32x32_bf16 v[64:79], v[20:23], v[56:63], v27
    ds_read_b128 v[20:23], v26 offset:6688
    v_exp_f32 v34, v34
    v_exp_f32 v35, v35
    v_exp_f32 v36, v36
    v_exp_f32 v37, v37
    s_waitcnt lgkmcnt(3)
    v_mfma_f32_32x32x8_bf16 v[48:63], v[10:11], v[8:9], 0
    ds_read_b64 v[10:11], v25 offset:1536
    v_exp_f32 v38, v38
    v_exp_f32 v39, v39
    v_exp_f32 v40, v40
    v_exp_f32 v41, v41
    s_waitcnt lgkmcnt(3)
    v_mfma_f32_32x32x16_bf16 v[48:63], v[12:15], v[4:7], v[48:63]
    ds_read2st64_b64 v[12:15], v24 offset0:12 offset1:13
    v_exp_f32 v42, v42
    v_exp_f32 v43, v43
    v_exp_f32 v44, v44
    v_exp_f32 v45, v45
    s_waitcnt lgkmcnt(3)
    v_smfmac_f32_32x32x32_bf16 v[64:79], v[16:19], v[32:39], v27
    ds_read_b128 v[16:19], v26 offset:6080
    v_exp_f32 v46, v46
    v_exp_f32 v47, v47
    v_exp_f32 v48, v48
    v_exp_f32 v49, v49
    s_waitcnt lgkmcnt(3)
    v_smfmac_f32_32x32x32_bf16 v[64:79], v[20:23], v[40:47], v27
    ds_read_b128 v[20:23], v26 offset:5472
    v_exp_f32 v50, v50
    v_exp_f32 v51, v51
    v_exp_f32 v52, v52
    v_exp_f32 v53, v53
    s_waitcnt lgkmcnt(3)
    v_mfma_f32_32x32x8_bf16 v[32:47], v[10:11], v[8:9], 0
    ds_read_b64 v[10:11], v98 offset:1536
    v_exp_f32 v54, v54
    v_exp_f32 v55, v55
    v_exp_f32 v56, v56
    v_exp_f32 v57, v57
    s_waitcnt lgkmcnt(3)
    v_mfma_f32_32x32x16_bf16 v[32:47], v[12:15], v[4:7], v[32:47]
    ds_read2st64_b64 v[12:15], v97 offset0:12 offset1:13
    v_exp_f32 v58, v58
    v_exp_f32 v59, v59
    v_exp_f32 v60, v60
    v_exp_f32 v61, v61
    s_waitcnt lgkmcnt(3)
    v_smfmac_f32_32x32x32_bf16 v[64:79], v[16:19], v[48:55], v27
    ds_read_b128 v[16:19], v26 offset:7296
    s_bitcmp1_b32 s28, s27
    v_exp_f32 v62, v62
    v_exp_f32 v63, v63
    s_cbranch_scc1 L_p2_event
L_p2_nobar:
    v_exp_f32 v32, v32
    v_exp_f32 v33, v33
    s_waitcnt lgkmcnt(3)
    v_smfmac_f32_32x32x32_bf16 v[64:79], v[20:23], v[56:63], v27
    ds_read_b128 v[20:23], v26 offset:9120
    v_exp_f32 v34, v34
    v_exp_f32 v35, v35
    v_exp_f32 v36, v36
    v_exp_f32 v37, v37
    s_waitcnt lgkmcnt(3)
    v_mfma_f32_32x32x8_bf16 v[48:63], v[10:11], v[8:9], 0
    ds_read_b64 v[10:11], v25 offset:2048
    v_exp_f32 v38, v38
    v_exp_f32 v39, v39
    v_exp_f32 v40, v40
    v_exp_f32 v41, v41
    s_waitcnt lgkmcnt(3)
    v_mfma_f32_32x32x16_bf16 v[48:63], v[12:15], v[4:7], v[48:63]
    ds_read2st64_b64 v[12:15], v24 offset0:16 offset1:17
    v_exp_f32 v42, v42
    v_exp_f32 v43, v43
    v_exp_f32 v44, v44
    v_exp_f32 v45, v45
    s_waitcnt lgkmcnt(3)
    v_smfmac_f32_32x32x32_bf16 v[64:79], v[16:19], v[32:39], v27
    ds_read_b128 v[16:19], v26 offset:8512
    v_exp_f32 v46, v46
    v_exp_f32 v47, v47
    v_exp_f32 v48, v48
    v_exp_f32 v49, v49
    s_waitcnt lgkmcnt(3)
    v_smfmac_f32_32x32x32_bf16 v[64:79], v[20:23], v[40:47], v27
    ds_read_b128 v[20:23], v26 offset:7904
    v_exp_f32 v50, v50
    v_exp_f32 v51, v51
    v_exp_f32 v52, v52
    v_exp_f32 v53, v53
    s_waitcnt lgkmcnt(3)
    v_mfma_f32_32x32x8_bf16 v[32:47], v[10:11], v[8:9], 0
    ds_read_b64 v[10:11], v98 offset:2048
    v_exp_f32 v54, v54
    v_exp_f32 v55, v55
    v_exp_f32 v56, v56
    v_exp_f32 v57, v57
    s_waitcnt lgkmcnt(3)
    v_mfma_f32_32x32x16_bf16 v[32:47], v[12:15], v[4:7], v[32:47]
    ds_read2st64_b64 v[12:15], v97 offset0:16 offset1:17
    v_exp_f32 v58, v58
    v_exp_f32 v59, v59
    v_exp_f32 v60, v60
    v_exp_f32 v61, v61
    s_waitcnt lgkmcnt(3)
    v_smfmac_f32_32x32x32_bf16 v[64:79], v[16:19], v[48:55], v27
    ds_read_b128 v[16:19], v26 offset:9728
    v_exp_f32 v62, v62
    v_exp_f32 v63, v63
    v_add_u32 v24, 8192, v24
    v_add_u32 v97, 8192, v97
    v_add_u32 v25, v80, v25
    v_add_u32 v98, v80, v98
    v_add_u32 v26, 9728, v26
    s_add_u32 s27, s27, 1
    s_cmp_lt_u32 s27, 8
    s_cbranch_scc1 L_p2_loop
    s_waitcnt lgkmcnt(0)
    v_smfmac_f32_32x32x32_bf16 v[64:79], v[20:23], v[56:63], v27
    s_setprio 3
L_p2_finish:
    s_nop 10
    v_mov_b32 v28, v74
    v_mov_b32 v29, v74
    v_mul_f32 v30, 0, v64
    v_cmp_gt_u32 vcc, 32, v1
    v_permlane32_swap_b32 v28, v29
    v_fma_f32 v30, v65, 0, v30
    v_fma_f32 v30, v66, 0, v30
    v_fma_f32 v30, v67, 0, v30
    v_fma_f32 v30, v68, 0, v30
    v_fma_f32 v30, v69, 0, v30
    v_fma_f32 v30, v70, 0, v30
    v_fma_f32 v30, v71, 0, v30
    v_fma_f32 v30, v28, 0, v30
    v_cndmask_b32 v72, 0, v72, vcc
    v_cndmask_b32 v73, 0, v73, vcc
    v_cmp_nle_f32 s[32:33], s29, v28
    v_fma_f32 v30, v72, 0, v30
    v_fma_f32 v30, v73, 0, v30
    v_rcp_f32 v28, v28
    v_cmp_u_f32 s[30:31], v30, v30
    s_nop 0
    s_or_b64 s[30:31], s[30:31], s[32:33]
    s_cmp_lg_u32 s27, 0xffff
    s_cselect_b64 s[30:31], s[30:31], 0
    s_cmp_lg_u64 s[30:31], 0
    s_cbranch_scc1 L_p2_fallback
    v_mul_f32 v64, v64, v28
    v_mul_f32 v65, v65, v28
    v_mul_f32 v66, v66, v28
    v_mul_f32 v67, v67, v28
    v_mul_f32 v68, v68, v28
    v_mul_f32 v69, v69, v28
    v_mul_f32 v70, v70, v28
    v_mul_f32 v71, v71, v28
    v_mul_f32 v72, v72, v28
    v_mul_f32 v73, v73, v28
    v_cvt_pk_bf16_f32 v32, v64, v65
    v_cvt_pk_bf16_f32 v33, v66, v67
    v_cvt_pk_bf16_f32 v34, v68, v69
    v_cvt_pk_bf16_f32 v35, v70, v71
    v_cvt_pk_bf16_f32 v36, v72, v73
    v_max_u32 v32, 1, v32
    v_max_u32 v33, 1, v33
    v_max_u32 v34, 1, v34
    v_max_u32 v35, 1, v35
    v_max_u32 v36, 1, v36
    v_permlane32_swap_b32 v32, v34
    v_permlane32_swap_b32 v33, v35
    s_nop 1
    buffer_store_dwordx4 v[32:35], v107, s[8:11], s54 offen sc1
    s_mov_b32 exec_hi, 0
    buffer_store_dword v36, v99, s[8:11], s55 offen sc1
    s_mov_b32 exec_hi, -1
    ds_add_u32 v96, v31 offset:132
    s_setprio 0
    s_cmp_lt_u32 s53, 2
    s_cbranch_scc1 L_tail_a
    s_waitcnt lgkmcnt(0)
    s_branch L_done
L_p2_event:
    s_cmp_lg_u32 s27, 3
    s_cbranch_scc1 L_p2_ev0
    s_cmp_ge_u32 s3, 4
    s_cselect_b64 vcc, -1, 0
L_p2_ev0:
    s_cmp_lg_u32 s27, 3
    s_cbranch_scc1 L_p2_ev1
    ds_add_u32 v96, v31 offset:120
L_p2_ev1:
    s_add_u32 s31, s27, 2
    s_cmp_lg_u32 s63, s31
    s_cbranch_scc1 L_hea_f
    s_waitcnt vmcnt(0)
    s_cmp_eq_u32 s60, 0
    s_cbranch_scc1 L_hea_d
    ds_add_rtn_u32 v30, v96, v31 offset:96
    s_waitcnt lgkmcnt(0)
    v_readfirstlane_b32 s30, v30
    s_cmp_lg_u32 s30, s60
    s_cbranch_scc1 L_hea_f
L_hea_d:
    v_mov_b32 v30, s39
    s_mov_b64 exec, 1
    buffer_store_dword v30, off, s[8:11], s61 sc1
    s_mov_b64 exec, -1
L_hea_f:
    s_add_u32 s31, s27, 3
    s_cmp_lg_u32 s63, s31
    s_cbranch_scc1 L_heb_s
    buffer_store_dwordx4 v[128:131], v160, s[8:11], 0 offen sc1
    buffer_store_dwordx4 v[132:135], v161, s[8:11], 0 offen sc1
    buffer_store_dwordx4 v[136:139], v162, s[8:11], 0 offen sc1
    buffer_store_dwordx4 v[140:143], v163, s[8:11], 0 offen sc1
    buffer_store_dwordx4 v[144:147], v164, s[8:11], 0 offen sc1
    buffer_store_dwordx4 v[148:151], v165, s[8:11], 0 offen sc1
    buffer_store_dwordx4 v[152:155], v166, s[8:11], 0 offen sc1
    buffer_store_dwordx4 v[156:159], v167, s[8:11], 0 offen sc1
L_heb_s:
    s_cmp_lg_u32 s27, 5
    s_cbranch_scc1 L_p2_ev2
    ds_add_u32 v96, v31 offset:124
L_p2_ev2:
    s_cmp_lg_u32 s27, 6
    s_cbranch_scc1 L_p2_ev4
    ds_add_u32 v96, v31 offset:168
L_p2_po:
    ds_read_b32 v30, v96 offset:136
    s_waitcnt lgkmcnt(0)
    v_readfirstlane_b32 s30, v30
    s_cmp_ge_u32 s30, 1
    s_cbranch_scc0 L_p2_po
L_p2_ev4:
    s_memrealtime s[24:25]
    s_lshl_b32 s31, s27, 1
    s_add_u32 s31, s31, 4
    s_bfm_b32 s38, s31, 0
L_p2_spin:
    ds_read_b32 v30, v96 offset:104
    s_waitcnt lgkmcnt(0)
    v_readfirstlane_b32 s30, v30
    s_andn2_b32 s31, s38, s30
    s_cbranch_scc1 L_p2_spin
    s_cmp_lg_u32 s27, 5
    s_cbranch_scc1 L_p2_ev5
    s_add_u32 s24, s24, s57
    v_mov_b32 v28, s39
    v_mov_b32 v29, s24
    s_mov_b64 exec, 1
    buffer_store_dwordx2 v[28:29], off, s[8:11], s56 sc1
    s_mov_b64 exec, -1
L_p2_ev5:
    s_cmp_eq_u32 s30, 0xffff
    s_cselect_b32 s28, 111, s28
    s_branch L_p2_nobar
L_p2_fallback:
    s_mov_b32 exec_lo, 0
    v_mov_b32 v8, 0
    s_mov_b32 exec_lo, -1
    v_subrev_u32 v24, 65536, v24
    v_and_b32 v25, 0x1ff, v24
    v_and_b32 v29, 31, v1
    v_lshrrev_b32 v26, 5, v1
    v_mul_u32_u24 v26, 9216, v26
    v_lshl_add_u32 v26, v29, 4, v26
    v_cmp_eq_u32 s[32:33], 18, v29
    v_mov_b32 v30, 0x3f803f80
    v_mov_b32 v28, 0xff800000
    s_mul_i32 s31, s21, 288
    s_add_u32 s31, s31, 5242880
    s_add_u32 s38, s21, 32
    s_mul_i32 s38, s38, 69888
    s_lshr_b32 s24, s21, 1
    s_add_u32 s24, s24, 16
    s_lshl_b32 s24, s24, 14
    s_add_u32 s24, s24, 9437184
    s_mov_b32 s27, 0
L_p2_fb1:
    s_lshr_b32 s28, s27, 1
    s_lshl_b32 s26, s28, 11
    s_add_u32 s26, s26, s38
    s_lshl_b32 s28, s28, 9
    s_add_u32 s28, s28, s24
    buffer_load_dwordx2 v[10:11], v25, s[8:11], s28 offen sc1
    buffer_load_dwordx2 v[12:13], v24, s[8:11], s26 offen sc1
    buffer_load_dwordx2 v[14:15], v24, s[8:11], s26 offen offset:512 sc1
    v_xor_b32 v24, 8, v24
    v_xor_b32 v25, 8, v25
    s_waitcnt vmcnt(0)
    v_mfma_f32_32x32x8_bf16 v[32:47], v[10:11], v[8:9], 0
    v_mfma_f32_32x32x16_bf16 v[32:47], v[12:15], v[4:7], v[32:47]
    s_nop 15
    v_max3_f32 v28, v28, v32, v33
    v_max3_f32 v28, v28, v34, v35
    v_max3_f32 v28, v28, v36, v37
    v_max3_f32 v28, v28, v38, v39
    v_max3_f32 v28, v28, v40, v41
    v_max3_f32 v28, v28, v42, v43
    v_max3_f32 v28, v28, v44, v45
    v_max3_f32 v28, v28, v46, v47
    s_add_u32 s27, s27, 1
    s_cmp_lt_u32 s27, 64
    s_cbranch_scc1 L_p2_fb1
    v_mov_b32 v29, v28
    s_nop 1
    v_permlane32_swap_b32 v28, v29
    s_mov_b32 s27, 0
    s_nop 1
    v_max_f32 v28, v28, v29
    v_mov_b32 v64, 0
    v_mov_b32 v65, 0
    v_mov_b32 v66, 0
    v_mov_b32 v67, 0
    v_mov_b32 v68, 0
    v_mov_b32 v69, 0
    v_mov_b32 v70, 0
    v_mov_b32 v71, 0
    v_mov_b32 v72, 0
    v_mov_b32 v73, 0
    v_mov_b32 v74, 0
    v_mov_b32 v75, 0
    v_mov_b32 v76, 0
    v_mov_b32 v77, 0
    v_mov_b32 v78, 0
    v_mov_b32 v79, 0
L_p2_fb2:
    s_lshr_b32 s28, s27, 1
    s_lshl_b32 s26, s28, 11
    s_add_u32 s26, s26, s38
    s_lshl_b32 s28, s28, 9
    s_add_u32 s28, s28, s24
    buffer_load_dwordx2 v[10:11], v25, s[8:11], s28 offen sc1
    buffer_load_dwordx2 v[12:13], v24, s[8:11], s26 offen sc1
    buffer_load_dwordx2 v[14:15], v24, s[8:11], s26 offen offset:512 sc1
    v_xor_b32 v24, 8, v24
    v_xor_b32 v25, 8, v25
    s_mul_i32 s26, s27, 36864
    s_add_u32 s26, s26, s31
    s_xor_b32 s28, s27, 1
    s_mul_i32 s28, s28, 36864
    s_add_u32 s28, s28, s31
    s_add_u32 s28, s28, 18432
    buffer_load_dwordx4 v[16:19], v26, s[8:11], s26 offen sc1
    buffer_load_dwordx4 v[20:23], v26, s[8:11], s28 offen sc1
    s_waitcnt vmcnt(0)
    v_cndmask_b32 v16, v16, v30, s[32:33]
    v_cndmask_b32 v17, v17, v30, s[32:33]
    v_cndmask_b32 v18, v18, v30, s[32:33]
    v_cndmask_b32 v19, v19, v30, s[32:33]
    v_cndmask_b32 v20, v20, v30, s[32:33]
    v_cndmask_b32 v21, v21, v30, s[32:33]
    v_cndmask_b32 v22, v22, v30, s[32:33]
    v_cndmask_b32 v23, v23, v30, s[32:33]
    v_mfma_f32_32x32x8_bf16 v[32:47], v[10:11], v[8:9], 0
    v_mfma_f32_32x32x16_bf16 v[32:47], v[12:15], v[4:7], v[32:47]
    s_nop 15
    v_sub_f32 v32, v32, v28
    v_sub_f32 v33, v33, v28
    v_sub_f32 v34, v34, v28
    v_sub_f32 v35, v35, v28
    v_sub_f32 v36, v36, v28
    v_sub_f32 v37, v37, v28
    v_sub_f32 v38, v38, v28
    v_sub_f32 v39, v39, v28
    v_sub_f32 v40, v40, v28
    v_sub_f32 v41, v41, v28
    v_sub_f32 v42, v42, v28
    v_sub_f32 v43, v43, v28
    v_sub_f32 v44, v44, v28
    v_sub_f32 v45, v45, v28
    v_sub_f32 v46, v46, v28
    v_sub_f32 v47, v47, v28
    v_exp_f32 v32, v32
    v_exp_f32 v33, v33
    v_exp_f32 v34, v34
    v_exp_f32 v35, v35
    v_exp_f32 v36, v36
    v_exp_f32 v37, v37
    v_exp_f32 v38, v38
    v_exp_f32 v39, v39
    v_exp_f32 v40, v40
    v_exp_f32 v41, v41
    v_exp_f32 v42, v42
    v_exp_f32 v43, v43
    v_exp_f32 v44, v44
    v_exp_f32 v45, v45
    v_exp_f32 v46, v46
    v_exp_f32 v47, v47
    s_nop 2
    v_smfmac_f32_32x32x32_bf16 v[64:79], v[16:19], v[32:39], v27
    v_smfmac_f32_32x32x32_bf16 v[64:79], v[20:23], v[40:47], v27
    s_add_u32 s27, s27, 1
    s_cmp_lt_u32 s27, 64
    s_cbranch_scc1 L_p2_fb2
    s_mov_b32 s27, 0xffff
    s_nop 15
    s_branch L_p2_finish
L_tail_a:
    s_cmp_eq_u32 s53, 1
    s_cbranch_scc1 L_p3_er
    s_mov_b64 s[58:59], 0
L_tail:
L_p3_w1:
    ds_read_b32 v105, v101 offset:128
    s_waitcnt lgkmcnt(0)
    v_readfirstlane_b32 s30, v105
    s_cmp_ge_u32 s30, 4
    s_cbranch_scc1 L_p3_w1_ok
    s_sleep 4
    s_branch L_p3_w1
L_p3_w1_ok:
    s_cmp_lg_u32 s52, 0
    s_cbranch_scc1 L_p3_w2
    ds_read_b64_tr_b16 v[64:65], v110 offset:0
    ds_read_b64_tr_b16 v[66:67], v110 offset:512
    ds_read_b64_tr_b16 v[68:69], v114 offset:0
    ds_read_b64_tr_b16 v[70:71], v114 offset:512
    ds_read_b64_tr_b16 v[72:73], v118 offset:0
    ds_read_b64_tr_b16 v[74:75], v118 offset:512
    ds_read_b64_tr_b16 v[76:77], v122 offset:0
    ds_read_b64_tr_b16 v[78:79], v122 offset:512
    ds_read_b64_tr_b16 v[80:81], v126 offset:0
    ds_read_b64_tr_b16 v[82:83], v126 offset:64
L_p3_w2:
    ds_read_b64_tr_b16 v[84:85], v110 offset:4096
    ds_read_b64_tr_b16 v[86:87], v110 offset:4608
    ds_read_b64_tr_b16 v[88:89], v114 offset:4096
    ds_read_b64_tr_b16 v[90:91], v114 offset:4608
    ds_read_b64_tr_b16 v[92:93], v118 offset:4096
    ds_read_b64_tr_b16 v[94:95], v118 offset:4608
    ds_read_b64_tr_b16 v[96:97], v122 offset:4096
    ds_read_b64_tr_b16 v[98:99], v122 offset:4608
    ds_read_b64_tr_b16 v[128:129], v126 offset:512
    ds_read_b64_tr_b16 v[130:131], v126 offset:576
    ds_read_b64_tr_b16 v[132:133], v110 offset:8192
    ds_read_b64_tr_b16 v[134:135], v110 offset:8704
    ds_read_b64_tr_b16 v[136:137], v114 offset:8192
    ds_read_b64_tr_b16 v[138:139], v114 offset:8704
    ds_read_b64_tr_b16 v[140:141], v118 offset:8192
    ds_read_b64_tr_b16 v[142:143], v118 offset:8704
    ds_read_b64_tr_b16 v[144:145], v122 offset:8192
    ds_read_b64_tr_b16 v[146:147], v122 offset:8704
    ds_read_b64_tr_b16 v[148:149], v126 offset:1024
    ds_read_b64_tr_b16 v[150:151], v126 offset:1088
    ds_read_b64_tr_b16 v[152:153], v110 offset:12288
    ds_read_b64_tr_b16 v[154:155], v110 offset:12800
    ds_read_b64_tr_b16 v[156:157], v114 offset:12288
    ds_read_b64_tr_b16 v[158:159], v114 offset:12800
    ds_read_b64_tr_b16 v[160:161], v118 offset:12288
    ds_read_b64_tr_b16 v[162:163], v118 offset:12800
    ds_read_b64_tr_b16 v[164:165], v122 offset:12288
    ds_read_b64_tr_b16 v[166:167], v122 offset:12800
    ds_read_b64_tr_b16 v[0:1], v126 offset:1536
    ds_read_b64_tr_b16 v[2:3], v126 offset:1600
    ds_read_b64_tr_b16 v[108:109], v110 offset:16384
    ds_read_b64_tr_b16 v[110:111], v110 offset:16896
    ds_read_b64_tr_b16 v[112:113], v114 offset:16384
    ds_read_b64_tr_b16 v[114:115], v114 offset:16896
    ds_read_b64_tr_b16 v[116:117], v118 offset:16384
    ds_read_b64_tr_b16 v[118:119], v118 offset:16896
    ds_read_b64_tr_b16 v[120:121], v122 offset:16384
    ds_read_b64_tr_b16 v[122:123], v122 offset:16896
    ds_read_b64_tr_b16 v[124:125], v126 offset:2048
    ds_read_b64_tr_b16 v[126:127], v126 offset:2112
L_p3_w3:
    s_mov_b32 s29, s52
    s_mov_b32 s33, 0
    s_mov_b32 s34, 0
    s_mov_b32 s63, -1
    s_add_u32 s26, s49, 4096
    s_add_u32 s27, s50, 4096
    v_mov_b64 v[4:5], 0
    v_mov_b64 v[6:7], 0
    v_mov_b64 v[8:9], 0
    v_mov_b64 v[10:11], 0
    v_mov_b64 v[12:13], 0
    v_mov_b64 v[14:15], 0
    v_mov_b64 v[16:17], 0
    v_mov_b64 v[18:19], 0
    v_mov_b64 v[20:21], 0
    v_mov_b64 v[22:23], 0
    v_mov_b64 v[24:25], 0
    v_mov_b64 v[26:27], 0
    v_mov_b64 v[28:29], 0
    v_mov_b64 v[30:31], 0
    v_mov_b64 v[32:33], 0
    v_mov_b64 v[34:35], 0
    v_mov_b64 v[36:37], 0
    v_mov_b64 v[38:39], 0
    v_mov_b64 v[40:41], 0
    v_mov_b64 v[42:43], 0
    s_setprio 0
    s_cmp_lg_u64 s[58:59], 0
    s_cbranch_scc1 L_p3_id1
    ds_read_b32 v102, v104
    s_memrealtime s[30:31]
L_p3_nx:
    s_waitcnt lgkmcnt(0)
    s_sub_u32 s30, s30, s39
    s_add_u32 s31, s30, 50
    v_cmp_ge_i32 vcc, s30, v102
    v_cmp_ge_i32 s[60:61], s31, v102
    s_lshr_b32 s33, s29, 8
    s_lshr_b32 s30, vcc_lo, s20
    s_lshr_b32 s35, vcc_hi, s20
    s_andn2_b32 s30, s30, s29
    s_and_b32 s32, s35, s29
    s_andn2_b32 s32, s32, s33
    s_or_b32 s33, s30, s32
    s_and_b32 s33, s33, 0x1f
    s_cbranch_scc0 L_p3_idle
    s_lshr_b32 s35, s60, s20
    s_andn2_b32 s35, s35, s29
    s_xor_b32 s35, s35, s30
    s_and_b32 s35, s35, 0x1f
    s_cbranch_scc1 L_p3_idle0
    s_and_b32 s35, s30, 0x1f
    s_cbranch_scc1 L_p3_go
    s_lshr_b32 s35, s61, s20
    s_and_b32 s35, s35, s29
    s_lshr_b32 s30, s29, 8
    s_andn2_b32 s35, s35, s30
    s_and_b32 s35, s35, 0x1f
    s_cmp_lg_u32 s35, s33
    s_cbranch_scc1 L_p3_idle0
L_p3_go:
    s_cmp_lg_u32 s34, 0
    s_cbranch_scc1 L_p3_pi
L_p3_pi1:
    s_bitcmp1_b32 s33, 0
    s_cselect_b32 s35, 0, 1073741824
    s_bitcmp1_b32 s29, 0
    v_or_b32 v105, s35, v100
    s_cselect_b32 s32, s50, s49
    buffer_load_dwordx4 v[44:47], v105, s[8:11], s32 offen offset:0 sc1
    s_bitcmp1_b32 s33, 1
    s_cselect_b32 s35, 0, 1073741824
    s_bitcmp1_b32 s29, 1
    v_or_b32 v105, s35, v100
    s_cselect_b32 s32, s50, s49
    buffer_load_dwordx4 v[48:51], v105, s[8:11], s32 offen offset:1024 sc1
    s_bitcmp1_b32 s33, 2
    s_cselect_b32 s35, 0, 1073741824
    s_bitcmp1_b32 s29, 2
    v_or_b32 v105, s35, v100
    s_cselect_b32 s32, s50, s49
    buffer_load_dwordx4 v[52:55], v105, s[8:11], s32 offen offset:2048 sc1
    s_bitcmp1_b32 s33, 3
    s_cselect_b32 s35, 0, 1073741824
    s_bitcmp1_b32 s29, 3
    v_or_b32 v105, s35, v100
    s_cselect_b32 s32, s50, s49
    buffer_load_dwordx4 v[56:59], v105, s[8:11], s32 offen offset:3072 sc1
    s_bitcmp1_b32 s33, 4
    s_cselect_b32 s35, 0, 1073741824
    s_bitcmp1_b32 s29, 4
    v_or_b32 v105, s35, v100
    s_cselect_b32 s32, s27, s26
    buffer_load_dwordx4 v[60:63], v105, s[8:11], s32 offen offset:0 sc1
L_p3_x9:
    s_and_b32 s35, s29, 0x1001f
    s_cmp_eq_u32 s35, 0x1f
    s_cbranch_scc1 L_p3_fl
L_p3_fl1:
    s_bitcmp1_b32 s33, 0
    s_cbranch_scc0 L_p3_s0
    s_bitcmp1_b32 s29, 0
    s_waitcnt vmcnt(4)
    s_cbranch_scc0 L_p3_e0
    v_mfma_f32_16x16x32_bf16 v[4:7], v[64:67], v[44:47], v[4:7]
    v_min3_u32 v105, v44, v45, v46
    v_mfma_f32_16x16x32_bf16 v[8:11], v[68:71], v[44:47], v[8:11]
    v_min_u32 v105, v105, v47
    v_mfma_f32_16x16x32_bf16 v[12:15], v[72:75], v[44:47], v[12:15]
    v_cmp_eq_u32 vcc, 0, v105
    v_mfma_f32_16x16x32_bf16 v[16:19], v[76:79], v[44:47], v[16:19]
    s_bitset1_b32 s29, 8
    v_mfma_f32_16x16x32_bf16 v[20:23], v[80:83], v[44:47], v[20:23]
    s_cbranch_vccnz L_p3_u0
L_p3_s0:
    s_bitcmp1_b32 s33, 1
    s_cbranch_scc0 L_p3_s1
    s_bitcmp1_b32 s29, 1
    s_waitcnt vmcnt(3)
    s_cbranch_scc0 L_p3_e1
    v_mfma_f32_16x16x32_bf16 v[4:7], v[84:87], v[48:51], v[4:7]
    v_min3_u32 v105, v48, v49, v50
    v_mfma_f32_16x16x32_bf16 v[8:11], v[88:91], v[48:51], v[8:11]
    v_min_u32 v105, v105, v51
    v_mfma_f32_16x16x32_bf16 v[12:15], v[92:95], v[48:51], v[12:15]
    v_cmp_eq_u32 vcc, 0, v105
    v_mfma_f32_16x16x32_bf16 v[16:19], v[96:99], v[48:51], v[16:19]
    s_bitset1_b32 s29, 9
    v_mfma_f32_16x16x32_bf16 v[20:23], v[128:131], v[48:51], v[20:23]
    s_cbranch_vccnz L_p3_u1
L_p3_s1:
    s_bitcmp1_b32 s33, 2
    s_cbranch_scc0 L_p3_s2
    s_bitcmp1_b32 s29, 2
    s_waitcnt vmcnt(2)
    s_cbranch_scc0 L_p3_e2
    v_mfma_f32_16x16x32_bf16 v[4:7], v[132:135], v[52:55], v[4:7]
    v_min3_u32 v105, v52, v53, v54
    v_mfma_f32_16x16x32_bf16 v[8:11], v[136:139], v[52:55], v[8:11]
    v_min_u32 v105, v105, v55
    v_mfma_f32_16x16x32_bf16 v[12:15], v[140:143], v[52:55], v[12:15]
    v_cmp_eq_u32 vcc, 0, v105
    v_mfma_f32_16x16x32_bf16 v[16:19], v[144:147], v[52:55], v[16:19]
    s_bitset1_b32 s29, 10
    v_mfma_f32_16x16x32_bf16 v[20:23], v[148:151], v[52:55], v[20:23]
    s_cbranch_vccnz L_p3_u2
L_p3_s2:
    s_bitcmp1_b32 s33, 3
    s_cbranch_scc0 L_p3_s3
    s_bitcmp1_b32 s29, 3
    s_waitcnt vmcnt(1)
    s_cbranch_scc0 L_p3_e3
    v_mfma_f32_16x16x32_bf16 v[4:7], v[152:155], v[56:59], v[4:7]
    v_min3_u32 v105, v56, v57, v58
    v_mfma_f32_16x16x32_bf16 v[8:11], v[156:159], v[56:59], v[8:11]
    v_min_u32 v105, v105, v59
    v_mfma_f32_16x16x32_bf16 v[12:15], v[160:163], v[56:59], v[12:15]
    v_cmp_eq_u32 vcc, 0, v105
    v_mfma_f32_16x16x32_bf16 v[16:19], v[164:167], v[56:59], v[16:19]
    s_bitset1_b32 s29, 11
    v_mfma_f32_16x16x32_bf16 v[20:23], v[0:3], v[56:59], v[20:23]
    s_cbranch_vccnz L_p3_u3
L_p3_s3:
    ds_read_b32 v102, v104
    s_memrealtime s[30:31]
    s_bitcmp1_b32 s33, 4
    s_cbranch_scc0 L_p3_s4
    s_bitcmp1_b32 s29, 4
    s_waitcnt vmcnt(0)
    s_cbranch_scc0 L_p3_e4
    v_mfma_f32_16x16x32_bf16 v[4:7], v[108:111], v[60:63], v[4:7]
    v_min3_u32 v105, v60, v61, v62
    v_mfma_f32_16x16x32_bf16 v[8:11], v[112:115], v[60:63], v[8:11]
    v_min_u32 v105, v105, v63
    v_mfma_f32_16x16x32_bf16 v[12:15], v[116:119], v[60:63], v[12:15]
    v_cmp_eq_u32 vcc, 0, v105
    v_mfma_f32_16x16x32_bf16 v[16:19], v[120:123], v[60:63], v[16:19]
    s_bitset1_b32 s29, 12
    v_mfma_f32_16x16x32_bf16 v[20:23], v[124:127], v[60:63], v[20:23]
    s_cbranch_vccnz L_p3_u4
L_p3_s4:
    s_cmp_lg_u32 s29, 0x11f1f
    s_cbranch_scc1 L_p3_nx
    s_branch L_p3_fin
L_p3_e0:
    v_mfma_f32_16x16x32_bf16 v[24:27], v[64:67], v[44:47], v[24:27]
    v_min3_u32 v105, v44, v45, v46
    v_mfma_f32_16x16x32_bf16 v[28:31], v[68:71], v[44:47], v[28:31]
    v_min_u32 v105, v105, v47
    v_mfma_f32_16x16x32_bf16 v[32:35], v[72:75], v[44:47], v[32:35]
    v_cmp_eq_u32 vcc, 0, v105
    v_mfma_f32_16x16x32_bf16 v[36:39], v[76:79], v[44:47], v[36:39]
    s_bitset1_b32 s29, 0
    v_mfma_f32_16x16x32_bf16 v[40:43], v[80:83], v[44:47], v[40:43]
    s_cbranch_vccnz L_p3_v0
    s_branch L_p3_s0
L_p3_e1:
    v_mfma_f32_16x16x32_bf16 v[24:27], v[84:87], v[48:51], v[24:27]
    v_min3_u32 v105, v48, v49, v50
    v_mfma_f32_16x16x32_bf16 v[28:31], v[88:91], v[48:51], v[28:31]
    v_min_u32 v105, v105, v51
    v_mfma_f32_16x16x32_bf16 v[32:35], v[92:95], v[48:51], v[32:35]
    v_cmp_eq_u32 vcc, 0, v105
    v_mfma_f32_16x16x32_bf16 v[36:39], v[96:99], v[48:51], v[36:39]
    s_bitset1_b32 s29, 1
    v_mfma_f32_16x16x32_bf16 v[40:43], v[128:131], v[48:51], v[40:43]
    s_cbranch_vccnz L_p3_v1
    s_branch L_p3_s1
L_p3_e2:
    v_mfma_f32_16x16x32_bf16 v[24:27], v[132:135], v[52:55], v[24:27]
    v_min3_u32 v105, v52, v53, v54
    v_mfma_f32_16x16x32_bf16 v[28:31], v[136:139], v[52:55], v[28:31]
    v_min_u32 v105, v105, v55
    v_mfma_f32_16x16x32_bf16 v[32:35], v[140:143], v[52:55], v[32:35]
    v_cmp_eq_u32 vcc, 0, v105
    v_mfma_f32_16x16x32_bf16 v[36:39], v[144:147], v[52:55], v[36:39]
    s_bitset1_b32 s29, 2
    v_mfma_f32_16x16x32_bf16 v[40:43], v[148:151], v[52:55], v[40:43]
    s_cbranch_vccnz L_p3_v2
    s_branch L_p3_s2
L_p3_e3:
    v_mfma_f32_16x16x32_bf16 v[24:27], v[152:155], v[56:59], v[24:27]
    v_min3_u32 v105, v56, v57, v58
    v_mfma_f32_16x16x32_bf16 v[28:31], v[156:159], v[56:59], v[28:31]
    v_min_u32 v105, v105, v59
    v_mfma_f32_16x16x32_bf16 v[32:35], v[160:163], v[56:59], v[32:35]
    v_cmp_eq_u32 vcc, 0, v105
    v_mfma_f32_16x16x32_bf16 v[36:39], v[164:167], v[56:59], v[36:39]
    s_bitset1_b32 s29, 3
    v_mfma_f32_16x16x32_bf16 v[40:43], v[0:3], v[56:59], v[40:43]
    s_cbranch_vccnz L_p3_v3
    s_branch L_p3_s3
L_p3_e4:
    v_mfma_f32_16x16x32_bf16 v[24:27], v[108:111], v[60:63], v[24:27]
    v_min3_u32 v105, v60, v61, v62
    v_mfma_f32_16x16x32_bf16 v[28:31], v[112:115], v[60:63], v[28:31]
    v_min_u32 v105, v105, v63
    v_mfma_f32_16x16x32_bf16 v[32:35], v[116:119], v[60:63], v[32:35]
    v_cmp_eq_u32 vcc, 0, v105
    v_mfma_f32_16x16x32_bf16 v[36:39], v[120:123], v[60:63], v[36:39]
    s_bitset1_b32 s29, 4
    v_mfma_f32_16x16x32_bf16 v[40:43], v[124:127], v[60:63], v[40:43]
    s_cbranch_vccnz L_p3_v4
    s_branch L_p3_s4
L_p3_u0:
    s_bitset0_b32 s29, 8
    s_mov_b32 s34, 1
    s_nop 4
    v_xor_b32 v44, 0x80008000, v44
    v_xor_b32 v45, 0x80008000, v45
    v_xor_b32 v46, 0x80008000, v46
    v_xor_b32 v47, 0x80008000, v47
    s_nop 1
    v_mfma_f32_16x16x32_bf16 v[4:7], v[64:67], v[44:47], v[4:7]
    v_mfma_f32_16x16x32_bf16 v[8:11], v[68:71], v[44:47], v[8:11]
    v_mfma_f32_16x16x32_bf16 v[12:15], v[72:75], v[44:47], v[12:15]
    v_mfma_f32_16x16x32_bf16 v[16:19], v[76:79], v[44:47], v[16:19]
    v_mfma_f32_16x16x32_bf16 v[20:23], v[80:83], v[44:47], v[20:23]
    s_branch L_p3_s0
L_p3_v0:
    s_bitset0_b32 s29, 0
    s_mov_b32 s34, 1
    s_nop 4
    v_xor_b32 v44, 0x80008000, v44
    v_xor_b32 v45, 0x80008000, v45
    v_xor_b32 v46, 0x80008000, v46
    v_xor_b32 v47, 0x80008000, v47
    s_nop 1
    v_mfma_f32_16x16x32_bf16 v[24:27], v[64:67], v[44:47], v[24:27]
    v_mfma_f32_16x16x32_bf16 v[28:31], v[68:71], v[44:47], v[28:31]
    v_mfma_f32_16x16x32_bf16 v[32:35], v[72:75], v[44:47], v[32:35]
    v_mfma_f32_16x16x32_bf16 v[36:39], v[76:79], v[44:47], v[36:39]
    v_mfma_f32_16x16x32_bf16 v[40:43], v[80:83], v[44:47], v[40:43]
    s_branch L_p3_s0
L_p3_u1:
    s_bitset0_b32 s29, 9
    s_mov_b32 s34, 1
    s_nop 4
    v_xor_b32 v48, 0x80008000, v48
    v_xor_b32 v49, 0x80008000, v49
    v_xor_b32 v50, 0x80008000, v50
    v_xor_b32 v51, 0x80008000, v51
    s_nop 1
    v_mfma_f32_16x16x32_bf16 v[4:7], v[84:87], v[48:51], v[4:7]
    v_mfma_f32_16x16x32_bf16 v[8:11], v[88:91], v[48:51], v[8:11]
    v_mfma_f32_16x16x32_bf16 v[12:15], v[92:95], v[48:51], v[12:15]
    v_mfma_f32_16x16x32_bf16 v[16:19], v[96:99], v[48:51], v[16:19]
    v_mfma_f32_16x16x32_bf16 v[20:23], v[128:131], v[48:51], v[20:23]
    s_branch L_p3_s1
L_p3_v1:
    s_bitset0_b32 s29, 1
    s_mov_b32 s34, 1
    s_nop 4
    v_xor_b32 v48, 0x80008000, v48
    v_xor_b32 v49, 0x80008000, v49
    v_xor_b32 v50, 0x80008000, v50
    v_xor_b32 v51, 0x80008000, v51
    s_nop 1
    v_mfma_f32_16x16x32_bf16 v[24:27], v[84:87], v[48:51], v[24:27]
    v_mfma_f32_16x16x32_bf16 v[28:31], v[88:91], v[48:51], v[28:31]
    v_mfma_f32_16x16x32_bf16 v[32:35], v[92:95], v[48:51], v[32:35]
    v_mfma_f32_16x16x32_bf16 v[36:39], v[96:99], v[48:51], v[36:39]
    v_mfma_f32_16x16x32_bf16 v[40:43], v[128:131], v[48:51], v[40:43]
    s_branch L_p3_s1
L_p3_u2:
    s_bitset0_b32 s29, 10
    s_mov_b32 s34, 1
    s_nop 4
    v_xor_b32 v52, 0x80008000, v52
    v_xor_b32 v53, 0x80008000, v53
    v_xor_b32 v54, 0x80008000, v54
    v_xor_b32 v55, 0x80008000, v55
    s_nop 1
    v_mfma_f32_16x16x32_bf16 v[4:7], v[132:135], v[52:55], v[4:7]
    v_mfma_f32_16x16x32_bf16 v[8:11], v[136:139], v[52:55], v[8:11]
    v_mfma_f32_16x16x32_bf16 v[12:15], v[140:143], v[52:55], v[12:15]
    v_mfma_f32_16x16x32_bf16 v[16:19], v[144:147], v[52:55], v[16:19]
    v_mfma_f32_16x16x32_bf16 v[20:23], v[148:151], v[52:55], v[20:23]
    s_branch L_p3_s2
L_p3_v2:
    s_bitset0_b32 s29, 2
    s_mov_b32 s34, 1
    s_nop 4
    v_xor_b32 v52, 0x80008000, v52
    v_xor_b32 v53, 0x80008000, v53
    v_xor_b32 v54, 0x80008000, v54
    v_xor_b32 v55, 0x80008000, v55
    s_nop 1
    v_mfma_f32_16x16x32_bf16 v[24:27], v[132:135], v[52:55], v[24:27]
    v_mfma_f32_16x16x32_bf16 v[28:31], v[136:139], v[52:55], v[28:31]
    v_mfma_f32_16x16x32_bf16 v[32:35], v[140:143], v[52:55], v[32:35]
    v_mfma_f32_16x16x32_bf16 v[36:39], v[144:147], v[52:55], v[36:39]
    v_mfma_f32_16x16x32_bf16 v[40:43], v[148:151], v[52:55], v[40:43]
    s_branch L_p3_s2
L_p3_u3:
    s_bitset0_b32 s29, 11
    s_mov_b32 s34, 1
    s_nop 4
    v_xor_b32 v56, 0x80008000, v56
    v_xor_b32 v57, 0x80008000, v57
    v_xor_b32 v58, 0x80008000, v58
    v_xor_b32 v59, 0x80008000, v59
    s_nop 1
    v_mfma_f32_16x16x32_bf16 v[4:7], v[152:155], v[56:59], v[4:7]
    v_mfma_f32_16x16x32_bf16 v[8:11], v[156:159], v[56:59], v[8:11]
    v_mfma_f32_16x16x32_bf16 v[12:15], v[160:163], v[56:59], v[12:15]
    v_mfma_f32_16x16x32_bf16 v[16:19], v[164:167], v[56:59], v[16:19]
    v_mfma_f32_16x16x32_bf16 v[20:23], v[0:3], v[56:59], v[20:23]
    s_branch L_p3_s3
L_p3_v3:
    s_bitset0_b32 s29, 3
    s_mov_b32 s34, 1
    s_nop 4
    v_xor_b32 v56, 0x80008000, v56
    v_xor_b32 v57, 0x80008000, v57
    v_xor_b32 v58, 0x80008000, v58
    v_xor_b32 v59, 0x80008000, v59
    s_nop 1
    v_mfma_f32_16x16x32_bf16 v[24:27], v[152:155], v[56:59], v[24:27]
    v_mfma_f32_16x16x32_bf16 v[28:31], v[156:159], v[56:59], v[28:31]
    v_mfma_f32_16x16x32_bf16 v[32:35], v[160:163], v[56:59], v[32:35]
    v_mfma_f32_16x16x32_bf16 v[36:39], v[164:167], v[56:59], v[36:39]
    v_mfma_f32_16x16x32_bf16 v[40:43], v[0:3], v[56:59], v[40:43]
    s_branch L_p3_s3
L_p3_u4:
    s_bitset0_b32 s29, 12
    s_mov_b32 s34, 1
    s_nop 4
    v_xor_b32 v60, 0x80008000, v60
    v_xor_b32 v61, 0x80008000, v61
    v_xor_b32 v62, 0x80008000, v62
    v_xor_b32 v63, 0x80008000, v63
    s_nop 1
    v_mfma_f32_16x16x32_bf16 v[4:7], v[108:111], v[60:63], v[4:7]
    v_mfma_f32_16x16x32_bf16 v[8:11], v[112:115], v[60:63], v[8:11]
    v_mfma_f32_16x16x32_bf16 v[12:15], v[116:119], v[60:63], v[12:15]
    v_mfma_f32_16x16x32_bf16 v[16:19], v[120:123], v[60:63], v[16:19]
    v_mfma_f32_16x16x32_bf16 v[20:23], v[124:127], v[60:63], v[20:23]
    s_branch L_p3_s4
L_p3_v4:
    s_bitset0_b32 s29, 4
    s_mov_b32 s34, 1
    s_nop 4
    v_xor_b32 v60, 0x80008000, v60
    v_xor_b32 v61, 0x80008000, v61
    v_xor_b32 v62, 0x80008000, v62
    v_xor_b32 v63, 0x80008000, v63
    s_nop 1
    v_mfma_f32_16x16x32_bf16 v[24:27], v[108:111], v[60:63], v[24:27]
    v_mfma_f32_16x16x32_bf16 v[28:31], v[112:115], v[60:63], v[28:31]
    v_mfma_f32_16x16x32_bf16 v[32:35], v[116:119], v[60:63], v[32:35]
    v_mfma_f32_16x16x32_bf16 v[36:39], v[120:123], v[60:63], v[36:39]
    v_mfma_f32_16x16x32_bf16 v[40:43], v[124:127], v[60:63], v[40:43]
    s_branch L_p3_s4
L_p3_pi:
    s_mov_b32 s34, 0
    s_sleep 2
    s_branch L_p3_pi1
L_p3_idle0:
    s_mov_b32 s33, 0
L_p3_idle:
    s_and_b32 s35, s29, 0x1001f
    s_cmp_eq_u32 s35, 0x1f
    s_cbranch_scc1 L_p3_fl
    s_cmp_lg_u64 s[58:59], 0
    s_cbranch_scc1 L_p3_id1
    s_sleep 4
    ds_read_b32 v102, v104
    s_memrealtime s[30:31]
    s_branch L_p3_nx
L_p3_id1:
    s_mov_b64 exec, s[58:59]
    buffer_load_dwordx2 v[66:67], v64, s[8:11], s4 offen sc1
    s_mov_b64 exec, -1
L_p3_id2:
    s_waitcnt vmcnt(0)
    v_cmp_ne_u32 vcc, s39, v66
    v_subrev_u32 v70, s39, v67
    s_mov_b64 s[58:59], vcc
    v_cndmask_b32 v70, v70, v65, vcc
    v_mov_b32 v71, v70
    s_nop 1
    v_permlane32_swap_b32 v70, v71
    s_nop 1
    v_sub_u32 v71, v71, v70
    v_mul_i32_i24 v71, 4, v71
    v_ashrrev_i32 v71, 3, v71
    s_mov_b32 exec_lo, 0
    v_add_u32 v70, v70, v71
    s_mov_b32 exec_lo, -1
    v_mov_b32 v72, v70
    s_nop 0
    s_nop 1
    v_max_i32_dpp v70, v70, v70 quad_perm:[1,0,3,2] row_mask:0xf bank_mask:0xf
    s_nop 1
    v_max_i32_dpp v71, v70, v70 quad_perm:[2,3,0,1] row_mask:0xf bank_mask:0xf
    ds_write_b32 v68, v70
    s_nop 0
    v_max_i32_dpp v71, v71, v71 row_half_mirror row_mask:0xf bank_mask:0xf
    s_nop 1
    v_max_i32_dpp v71, v71, v71 row_mirror row_mask:0xf bank_mask:0xf
    ds_write_b32 v69, v71
    s_cbranch_vccz L_p3_id3
    s_sleep 8
    ds_read_b32 v102, v104
    s_memrealtime s[30:31]
    s_branch L_p3_nx
L_p3_id3:
    ds_read_b32 v102, v104
    s_memrealtime s[30:31]
    s_branch L_p3_nx
L_p3_fl:
L_p3_pg2:
    ds_read_b32 v105, v101 offset:168
    s_waitcnt lgkmcnt(0)
    v_readfirstlane_b32 s35, v105
    s_cmp_ge_u32 s35, 8
    s_cbranch_scc0 L_p3_pg2
    v_mov_b32 v105, 1
    v_add_u32 v102, s6, v100
    v_add_u32 v103, s5, v101
    ds_write_b128 v102, v[24:27] offset:0
    ds_write_b128 v102, v[28:31] offset:1024
    ds_write_b128 v102, v[32:35] offset:2048
    ds_write_b128 v102, v[36:39] offset:3072
    s_mov_b32 exec_hi, 0
    ds_write_b128 v102, v[40:43] offset:4096
    ds_add_u32 v103, v105 offset:140
    s_mov_b32 exec_hi, -1
    s_bitset1_b32 s29, 16
    s_cmp_lg_u32 s33, 0
    s_cbranch_scc1 L_p3_fl1
    s_waitcnt lgkmcnt(0)
    ds_read_b32 v102, v104
    s_memrealtime s[30:31]
    s_branch L_p3_nx
L_p3_er:
    v_add_u32 v104, s5, v101
    v_add_u32 v44, s6, v100
L_p3_er1:
    ds_read_b32 v46, v104 offset:140
    s_waitcnt lgkmcnt(0)
    v_readfirstlane_b32 s30, v46
    s_cmp_ge_u32 s30, 4
    s_cbranch_scc1 L_p3_er1_ok
    s_sleep 4
    s_branch L_p3_er1
L_p3_er1_ok:
    ds_read_b128 v[4:7], v44 offset:0
    ds_read_b128 v[8:11], v44 offset:1024
    ds_read_b128 v[12:15], v44 offset:2048
    ds_read_b128 v[16:19], v44 offset:3072
    ds_read_b128 v[20:23], v44 offset:4096
    v_add_u32 v44, s51, v100
    s_waitcnt lgkmcnt(0)
    s_branch L_p3_red
L_p3_fin:
    v_add_u32 v104, s5, v101
    v_mov_b32 v105, 1
    ds_add_rtn_u32 v46, v104, v105 offset:148
    ds_read_b32 v103, v104 offset:172
    ds_read_b32 v102, v101 offset:132
    v_add_u32 v44, s51, v100
    s_waitcnt lgkmcnt(0)
    v_readfirstlane_b32 s30, v46
    v_readfirstlane_b32 s31, v103
    v_readfirstlane_b32 s35, v102
    s_cmp_eq_u32 s30, 3
    s_cbranch_scc1 L_p3_last
    s_mul_i32 s30, s30, 4608
    v_add_u32 v44, s30, v44
    s_cmp_ge_u32 s35, 8
    s_cbranch_scc1 L_p3_adok
L_p3_ad:
    ds_read_b32 v102, v101 offset:132
    s_waitcnt lgkmcnt(0)
    v_readfirstlane_b32 s35, v102
    s_cmp_ge_u32 s35, 8
    s_cbranch_scc1 L_p3_ad_ok
    s_sleep 2
    s_branch L_p3_ad
L_p3_ad_ok:
L_p3_adok:
    ds_write_b128 v44, v[4:7] offset:0
    ds_write_b128 v44, v[8:11] offset:1024
    ds_write_b128 v44, v[12:15] offset:2048
    ds_write_b128 v44, v[16:19] offset:3072
    s_mov_b32 exec_hi, 0
    ds_write_b128 v44, v[20:23] offset:4096
    ds_add_u32 v104, v105 offset:172
    s_mov_b32 exec_hi, -1
    s_waitcnt lgkmcnt(0)
    s_branch L_done
L_p3_last:
    s_cmp_eq_u32 s31, 3
    s_cbranch_scc1 L_p3_red
L_p3_rb:
    ds_read_b32 v46, v104 offset:172
    s_waitcnt lgkmcnt(0)
    v_readfirstlane_b32 s30, v46
    s_cmp_ge_u32 s30, 3
    s_cbranch_scc0 L_p3_rb
L_p3_red:
    ds_read_b128 v[108:111], v44 offset:0
    ds_read_b128 v[112:115], v44 offset:4608
    ds_read_b128 v[116:119], v44 offset:9216
    ds_read_b128 v[120:123], v44 offset:1024
    ds_read_b128 v[124:127], v44 offset:5632
    ds_read_b128 v[128:131], v44 offset:10240
    ds_read_b128 v[132:135], v44 offset:2048
    ds_read_b128 v[136:139], v44 offset:6656
    ds_read_b128 v[140:143], v44 offset:11264
    ds_read_b128 v[144:147], v44 offset:3072
    ds_read_b128 v[148:151], v44 offset:7680
    ds_read_b128 v[152:155], v44 offset:12288
    ds_read_b128 v[156:159], v44 offset:4096
    ds_read_b128 v[160:163], v44 offset:8704
    ds_read_b128 v[164:167], v44 offset:13312
    v_bfe_u32 v45, v100, 4, 4
    v_mul_u32_u24 v45, 2304, v45
    v_lshrrev_b32 v46, 8, v100
    v_lshl_add_u32 v45, v46, 3, v45
    s_waitcnt lgkmcnt(12)
    v_pk_add_f32 v[4:5], v[4:5], v[108:109]
    v_pk_add_f32 v[6:7], v[6:7], v[110:111]
    v_pk_add_f32 v[112:113], v[112:113], v[116:117]
    v_pk_add_f32 v[114:115], v[114:115], v[118:119]
    v_pk_add_f32 v[4:5], v[4:5], v[112:113]
    v_pk_add_f32 v[6:7], v[6:7], v[114:115]
    v_cvt_pk_bf16_f32 v4, v4, v5
    v_cvt_pk_bf16_f32 v5, v6, v7
    buffer_store_dwordx2 v[4:5], v45, s[12:15], s48 offen offset:0
    s_waitcnt lgkmcnt(9)
    v_pk_add_f32 v[8:9], v[8:9], v[120:121]
    v_pk_add_f32 v[10:11], v[10:11], v[122:123]
    v_pk_add_f32 v[124:125], v[124:125], v[128:129]
    v_pk_add_f32 v[126:127], v[126:127], v[130:131]
    v_pk_add_f32 v[8:9], v[8:9], v[124:125]
    v_pk_add_f32 v[10:11], v[10:11], v[126:127]
    v_cvt_pk_bf16_f32 v8, v8, v9
    v_cvt_pk_bf16_f32 v9, v10, v11
    buffer_store_dwordx2 v[8:9], v45, s[12:15], s48 offen offset:32
    s_waitcnt lgkmcnt(6)
    v_pk_add_f32 v[12:13], v[12:13], v[132:133]
    v_pk_add_f32 v[14:15], v[14:15], v[134:135]
    v_pk_add_f32 v[136:137], v[136:137], v[140:141]
    v_pk_add_f32 v[138:139], v[138:139], v[142:143]
    v_pk_add_f32 v[12:13], v[12:13], v[136:137]
    v_pk_add_f32 v[14:15], v[14:15], v[138:139]
    v_cvt_pk_bf16_f32 v12, v12, v13
    v_cvt_pk_bf16_f32 v13, v14, v15
    buffer_store_dwordx2 v[12:13], v45, s[12:15], s48 offen offset:64
    s_waitcnt lgkmcnt(3)
    v_pk_add_f32 v[16:17], v[16:17], v[144:145]
    v_pk_add_f32 v[18:19], v[18:19], v[146:147]
    v_pk_add_f32 v[148:149], v[148:149], v[152:153]
    v_pk_add_f32 v[150:151], v[150:151], v[154:155]
    v_pk_add_f32 v[16:17], v[16:17], v[148:149]
    v_pk_add_f32 v[18:19], v[18:19], v[150:151]
    v_cvt_pk_bf16_f32 v16, v16, v17
    v_cvt_pk_bf16_f32 v17, v18, v19
    buffer_store_dwordx2 v[16:17], v45, s[12:15], s48 offen offset:96
    s_waitcnt lgkmcnt(0)
    v_pk_add_f32 v[20:21], v[20:21], v[156:157]
    v_pk_add_f32 v[22:23], v[22:23], v[158:159]
    v_pk_add_f32 v[160:161], v[160:161], v[164:165]
    v_pk_add_f32 v[162:163], v[162:163], v[166:167]
    v_pk_add_f32 v[20:21], v[20:21], v[160:161]
    v_pk_add_f32 v[22:23], v[22:23], v[162:163]
    v_cvt_pk_bf16_f32 v20, v20, v21
    v_cvt_pk_bf16_f32 v21, v22, v23
    s_mov_b32 exec_hi, 0
    buffer_store_dwordx2 v[20:21], v45, s[12:15], s48 offen offset:128
    s_mov_b32 exec_hi, -1
L_done:
L_end:
    s_endpgm
.section .rodata,"a"
.p2align 6
.amdhsa_kernel concat_heads__spectral_fnet__softmax_full_mha__prompt_kernel
  .amdhsa_next_free_vgpr 168
  .amdhsa_next_free_sgpr 102
  .amdhsa_accum_offset 168
  .amdhsa_group_segment_fixed_size 0
  .amdhsa_kernarg_size 88
  .amdhsa_user_sgpr_count 2
  .amdhsa_user_sgpr_kernarg_segment_ptr 1
  .amdhsa_system_sgpr_workgroup_id_x 1
.end_amdhsa_kernel
```
